```python
import torch

def _softmax(x, axis=-1):
    return torch.softmax(x, dim=axis)
def _gelu(x):
    return torch.nn.functional.gelu(x, approximate="tanh")
def _silu(x):
    return torch.nn.functional.silu(x)
def _sigmoid(x):
    return torch.sigmoid(x)
def _layernorm(x, axis=-1, eps=1e-5):
    m = x.mean(dim=axis, keepdim=True)
    v = x.var(dim=axis, keepdim=True, unbiased=False)
    return (x - m) / torch.sqrt(v + eps)
def _scatter_add(tgt, idx, src, axis=0):
    return tgt.clone().index_add_(axis, idx, src)
def _segment_sum(src, seg, n):
    out = torch.zeros((n,) + src.shape[1:], dtype=src.dtype)
    return out.index_add_(0, seg, src)
def _pad(x, pw):
    flat = tuple(v for pair in reversed(pw) for v in pair)
    return torch.nn.functional.pad(x, flat)

kernel_name = 'sequential_preLN__grouped_kv_mqa__dense_activation_relu__prompt'

def setup_inputs():

    _w = (lambda a: (lambda t: t.to(torch.bfloat16) if t.is_floating_point() else t)(torch.as_tensor(a)))
    def _A_setup():
        B, S, D, H = 1, 2048, 640, 32
        Dh = D // H
        return {
            "x": _w((lambda *s: torch.randn(*s, dtype=torch.bfloat16) * 0.05)(B, S, D)),
            "wq": _w((lambda *s: torch.randn(*s, dtype=torch.bfloat16) * 0.05)(D, H * Dh)),
            "wk": _w((lambda *s: torch.randn(*s, dtype=torch.bfloat16) * 0.05)(D, Dh)),
            "wv": _w((lambda *s: torch.randn(*s, dtype=torch.bfloat16) * 0.05)(D, Dh)),
            "wo": _w((lambda *s: torch.randn(*s, dtype=torch.bfloat16) * 0.05)(H * Dh, D)),
        }
    _A_in = _A_setup()

    def _B_setup():
        B, S, D, Dff = 1, 2048, 640, 1536
        return {
            "x": _w((lambda *s: torch.randn(*s, dtype=torch.bfloat16) * 0.05)(B, S, D)),
            "w1": _w((lambda *s: torch.randn(*s, dtype=torch.bfloat16) * 0.05)(D, Dff)),
            "w2": _w((lambda *s: torch.randn(*s, dtype=torch.bfloat16) * 0.05)(Dff, D)),
        }
    _B_in = _B_setup()

    return {
        "A_x": _A_in["x"],
        "A_wq": _A_in["wq"],
        "A_wk": _A_in["wk"],
        "A_wv": _A_in["wv"],
        "A_wo": _A_in["wo"],
        "B_x": _B_in["x"],
        "B_w1": _B_in["w1"],
        "B_w2": _B_in["w2"],
    }

def reference(A_x, A_wq, A_wk, A_wv, A_wo, B_x, B_w1, B_w2):
    def _A_ref(x, wq, wk, wv, wo):
        B, S, D = x.shape
        H = 32
        Dh = D // H
        q = (lambda x, *d: x.permute(*d))((x @ wq).reshape(B, S, H, Dh), 0, 2, 1, 3)
        k = x @ wk
        v = x @ wv
        scores = torch.einsum("bhqd,bkd->bhqk", q, k) * (Dh ** -0.5)
        p = _softmax(scores, axis=-1)
        o = torch.einsum("bhqk,bkd->bhqd", p, v)
        return (lambda x, *d: x.permute(*d))(o, 0, 2, 1, 3).reshape(B, S, H * Dh) @ wo

    def _B_ref(x, w1, w2):
        h = torch.einsum("bsd,df->bsf", x, w1)
        zero = torch.zeros_like(h)
        h = torch.maximum(h, zero)
        return torch.einsum("bsf,fd->bsd", h, w2)

    x = A_x
    h = x + _A_ref(_layernorm(x, axis=-1), A_wq, A_wk, A_wv, A_wo)
    h2 = h + _B_ref(_layernorm(h, axis=-1), B_w1, B_w2)
    return h2
```

```asm
; @launch grid=(256,1,1) block=(512,1,1) lds=163840
.amdgcn_target "amdgcn-amd-amdhsa--gfx950"
.text
.globl sequential_preLN__grouped_kv_mqa__dense_activation_relu__prompt_kernel
.p2align 8
.type sequential_preLN__grouped_kv_mqa__dense_activation_relu__prompt_kernel,@function
sequential_preLN__grouped_kv_mqa__dense_activation_relu__prompt_kernel:
L_start:
    s_getpc_b64 s[34:35]
    s_cmp_ge_u32 s2, 256
    s_cbranch_scc1 L_end
    s_load_dwordx4 s[20:23], s[0:1], 16
    s_lshr_b32 s64, s2, 3
    s_lshl_b32 s65, s64, 9
    v_add_lshl_u32 v7, v0, s65, 2
    v_min_u32 v7, L_codeend-L_start-8, v7
    global_load_dword v136, v7, s[34:35]
    s_load_dwordx2 s[4:5], s[0:1], 0
    s_load_dwordx2 s[8:9], s[0:1], 8
    s_load_dwordx2 s[12:13], s[0:1], 80
    s_load_dwordx2 s[40:41], s[0:1], 32
    s_load_dwordx4 s[28:31], s[0:1], 48
    s_load_dwordx2 s[44:45], s[0:1], 64
    v_lshrrev_b32 v6, 6, v0
    v_and_b32 v1, 63, v0
    v_readfirstlane_b32 s48, v6
    v_lshlrev_b32 v2, 4, v1
    v_lshrrev_b32 v9, 4, v1
    v_sub_u32 v9, 0, v9
    v_xor_b32 v9, v9, v1
    v_and_b32 v9, 3, v9
    v_lshrrev_b32 v30, 2, v1
    v_mul_u32_u24 v30, 1280, v30
    v_lshl_add_u32 v30, v9, 4, v30
    s_and_b32 s65, s2, 7
    s_lshl_b32 s65, s65, 2
    s_and_b32 s64, s64, 3
    s_add_u32 s51, s65, s64
    s_lshr_b32 s52, s2, 5
    s_and_b32 s49, s48, 3
    s_lshr_b32 s50, s48, 2
    s_lshr_b32 s68, s52, 1
    s_mov_b32 s6, 2621440
    s_mov_b32 s7, 0x20000
    s_mul_i32 s26, s51, 81920
    s_mul_i32 s72, s49, 320
    s_add_u32 s72, s72, s26
    s_mul_i32 s75, s49, 5120
    s_cmp_ge_u32 s48, 4
    s_cbranch_scc1 L_hi
    s_mul_i32 s70, s48, 6656
    s_add_u32 s70, s70, 122880
    s_mul_i32 s71, s48, 6400
    s_mov_b32 m0, s70
    s_mov_b32 s38, 25600
    s_mov_b32 s39, 0x20000
    s_bitcmp1_b32 s52, 0
    s_waitcnt lgkmcnt(0)
    s_cselect_b32 s36, s22, s20
    s_cselect_b32 s37, s23, s21
    buffer_load_dwordx4 v2, s[36:39], s71 offen offset:0 lds
    buffer_load_dwordx4 v2, s[36:39], s71 offen offset:1024 lds
    buffer_load_dwordx4 v2, s[36:39], s71 offen offset:2048 lds
    buffer_load_dwordx4 v2, s[36:39], s71 offen offset:3072 lds
    s_mov_b32 s10, 819200
    s_mov_b32 s11, 0x20000
    s_mov_b32 s14, 67108864
    s_mov_b32 s15, 0x20000
    s_mov_b32 s46, 2621440
    s_mov_b32 s47, 0x20000
    s_mul_i32 s53, s52, 160
    s_lshl_b32 s55, s51, 19
    s_add_u32 s55, s55, 8388608
    s_mov_b32 s60, 0x3f803f80
    s_and_b32 s59, s51, 1
    s_add_u32 m0, s70, 4096
    s_add_u32 s71, s71, 4096
    buffer_load_dwordx4 v2, s[36:39], s71 offen lds
    s_mul_i32 s59, s59, 5
    s_mov_b32 s61, 0
    s_mov_b32 s63, 0
    s_mov_b32 s27, 986500301
    s_mov_b32 s32, 925353388
    s_mov_b32 s62, 200000
    v_bfe_u32 v6, v1, 4, 1
    v_mul_u32_u24 v5, 20480, v6
    v_lshlrev_b32 v244, 3, v6
    v_and_b32 v6, 15, v1
    v_lshl_add_u32 v5, v6, 4, v5
    buffer_load_dwordx4 v2, s[36:39], s71 offen offset:1024 lds
    v_lshrrev_b32 v7, 5, v1
    v_lshl_add_u32 v5, v7, 8, v5
    v_bfe_u32 v11, v1, 2, 2
    v_sub_u32 v9, 0, v11
    v_xor_b32 v7, v7, v9
    v_and_b32 v7, 3, v7
    v_lshl_add_u32 v244, v7, 4, v244
    v_lshl_add_u32 v244, v6, 6, v244
    v_lshrrev_b32 v10, 4, v1
    v_xor_b32 v9, v9, v10
    v_and_b32 v9, 3, v9
    s_mov_b32 exec_hi, 0
    buffer_load_dwordx4 v2, s[36:39], s71 offen offset:2048 lds
    s_mov_b64 exec, -1
    v_lshlrev_b32 v9, 4, v9
    v_lshl_add_u32 v8, v6, 6, v9
    v_lshl_add_u32 v7, v10, 3, v11
    v_and_b32 v9, 1, v10
    v_lshl_add_u32 v3, v9, 2, v7
    v_xor_b32 v4, 4, v3
    v_and_b32 v9, 3, v1
    v_lshlrev_b32 v9, 3, v9
    s_mul_i32 s69, s50, 5120
    s_add_u32 s69, s69, 81920
    v_add_u32 v9, s69, v9
    s_mul_i32 s76, s68, 20480
    s_add_u32 s58, s72, s76
    s_add_u32 s76, s76, s75
    s_movk_i32 s69, 160
    v_mad_u32_u24 v3, v3, s69, v9
    v_mad_u32_u24 v4, v4, s69, v9
    s_lshr_b32 s64, s49, 1
    s_mul_i32 s64, s64, 5120
    s_mul_i32 s65, s50, 3072
    s_add_u32 s64, s64, s65
    s_and_b32 s65, s49, 1
    s_lshl_b32 s65, s65, 7
    s_add_u32 s64, s64, s65
    s_add_u32 s64, s64, 102400
    s_add_u32 m0, s76, 0
    s_nop 0
    buffer_load_dwordx4 v30, s[4:7], s58 offen offset:0 lds
    v_lshlrev_b32 v27, 8, v10
    v_lshl_add_u32 v27, v6, 3, v27
    v_add_u32 v27, s64, v27
    v_mul_u32_u24 v85, 40, v7
    v_add_u32 v85, s70, v85
    v_and_b32 v9, 3, v1
    v_lshl_add_u32 v84, v9, 3, v85
    s_lshl_b32 s65, s48, 11
    s_add_u32 s65, s65, 149504
    v_add_u32 v87, s65, v2
    s_lshl_b32 s65, s48, 8
    s_add_u32 m0, s76, 960
    s_nop 0
    buffer_load_dwordx4 v30, s[4:7], s58 offen offset:64 lds
    s_add_u32 s65, s65, 157696
    v_lshl_add_u32 v242, v1, 2, s65
    v_mov_b32 v240, 158848
    v_mov_b32 v241, 1
    v_mov_b32 v80, 0
    v_mov_b32 v81, 0
    v_mov_b32 v82, 0
    v_mov_b32 v83, 0
    s_mul_i32 s69, s49, 20480
    s_mul_i32 s65, s50, 10240
    s_add_u32 s79, s69, s65
    s_add_u32 m0, s76, 1920
    s_nop 0
    buffer_load_dwordx4 v30, s[4:7], s58 offen offset:128 lds
    s_mul_i32 s64, s52, 5
    s_add_u32 s65, s64, 4
    s_and_b32 s66, s65, 1
    s_lshl_b32 s66, s66, 5
    s_lshr_b32 s65, s65, 1
    s_lshl_b32 s65, s65, 10
    s_add_u32 s65, s65, s69
    v_xor_b32 v246, s66, v244
    v_add_u32 v246, s65, v246
    s_lshl_b32 s65, s50, 1
    s_add_u32 s65, s65, s64
    s_add_u32 m0, s76, 2880
    s_nop 0
    buffer_load_dwordx4 v30, s[4:7], s58 offen offset:192 lds
    s_add_u32 s65, s65, 1
    s_and_b32 s66, s65, 1
    s_lshl_b32 s66, s66, 5
    s_lshr_b32 s65, s65, 1
    s_lshl_b32 s65, s65, 10
    s_add_u32 s65, s65, s69
    v_xor_b32 v245, s66, v244
    v_add_u32 v245, s65, v245
    s_lshl_b32 s65, s50, 1
    s_add_u32 s65, s65, s64
    s_and_b32 s66, s65, 1
    s_add_u32 m0, s76, 3840
    s_nop 0
    buffer_load_dwordx4 v30, s[4:7], s58 offen offset:256 lds
    s_lshl_b32 s66, s66, 5
    s_lshr_b32 s65, s65, 1
    s_lshl_b32 s65, s65, 10
    s_add_u32 s65, s65, s69
    v_xor_b32 v244, s66, v244
    v_add_u32 v244, s65, v244
    v_mov_b32 v248, s60
    v_mov_b32 v249, s60
    v_mov_b32 v250, s60
    v_mov_b32 v251, s60
    v_add_u32 v86, s76, v8
    s_barrier
    buffer_load_dword v243, off, s[12:15], 0 offset:0 sc1
    s_waitcnt vmcnt(6)
    ds_read_b64_tr_b16 v[32:33], v84 offset:0
    ds_read_b64_tr_b16 v[34:35], v84 offset:160
    ds_read_b64_tr_b16 v[36:37], v85 offset:32
    ds_read_b64_tr_b16 v[38:39], v85 offset:192
    ds_read_b64_tr_b16 v[40:41], v84 offset:1280
    ds_read_b64_tr_b16 v[42:43], v84 offset:1440
    ds_read_b64_tr_b16 v[44:45], v85 offset:1312
    ds_read_b64_tr_b16 v[46:47], v85 offset:1472
    ds_read_b64_tr_b16 v[48:49], v84 offset:2560
    ds_read_b64_tr_b16 v[50:51], v84 offset:2720
    ds_read_b64_tr_b16 v[52:53], v85 offset:2592
    ds_read_b64_tr_b16 v[54:55], v85 offset:2752
    s_waitcnt lgkmcnt(0)
    ds_read_b64_tr_b16 v[56:57], v84 offset:3840
    ds_read_b64_tr_b16 v[58:59], v84 offset:4000
    ds_read_b64_tr_b16 v[60:61], v85 offset:3872
    ds_read_b64_tr_b16 v[62:63], v85 offset:4032
    ds_read_b64_tr_b16 v[64:65], v84 offset:5120
    ds_read_b64_tr_b16 v[66:67], v84 offset:5280
    ds_read_b64_tr_b16 v[68:69], v85 offset:5152
    ds_read_b64_tr_b16 v[70:71], v85 offset:5312
    v_dot2c_f32_bf16 v82, s60, v32
    v_dot2c_f32_bf16 v82, s60, v33
    v_dot2c_f32_bf16 v82, s60, v34
    v_dot2c_f32_bf16 v82, s60, v35
    v_dot2c_f32_bf16 v83, s60, v36
    v_dot2c_f32_bf16 v83, s60, v37
    v_dot2c_f32_bf16 v83, s60, v38
    v_dot2c_f32_bf16 v83, s60, v39
    v_dot2c_f32_bf16 v82, s60, v40
    v_dot2c_f32_bf16 v82, s60, v41
    v_dot2c_f32_bf16 v82, s60, v42
    v_dot2c_f32_bf16 v82, s60, v43
    v_dot2c_f32_bf16 v83, s60, v44
    v_dot2c_f32_bf16 v83, s60, v45
    v_dot2c_f32_bf16 v83, s60, v46
    v_dot2c_f32_bf16 v83, s60, v47
    v_dot2c_f32_bf16 v82, s60, v48
    v_dot2c_f32_bf16 v82, s60, v49
    v_dot2c_f32_bf16 v82, s60, v50
    v_dot2c_f32_bf16 v82, s60, v51
    v_dot2c_f32_bf16 v83, s60, v52
    v_dot2c_f32_bf16 v83, s60, v53
    v_dot2c_f32_bf16 v83, s60, v54
    v_dot2c_f32_bf16 v83, s60, v55
    s_waitcnt lgkmcnt(0)
    v_dot2c_f32_bf16 v82, s60, v56
    v_dot2c_f32_bf16 v82, s60, v57
    v_dot2c_f32_bf16 v82, s60, v58
    v_dot2c_f32_bf16 v82, s60, v59
    v_dot2c_f32_bf16 v83, s60, v60
    v_dot2c_f32_bf16 v83, s60, v61
    v_dot2c_f32_bf16 v83, s60, v62
    v_dot2c_f32_bf16 v83, s60, v63
    s_waitcnt vmcnt(1)
    ds_read_b128 v[144:147], v86 offset:0
    ds_read_b128 v[148:151], v86 offset:1024
    ds_read_b128 v[152:155], v86 offset:2048
    ds_read_b128 v[156:159], v86 offset:3072
    ds_read_b128 v[160:163], v86 offset:4096
    v_dot2c_f32_bf16 v82, s60, v64
    v_dot2c_f32_bf16 v82, s60, v65
    v_dot2c_f32_bf16 v82, s60, v66
    v_dot2c_f32_bf16 v82, s60, v67
    v_dot2c_f32_bf16 v83, s60, v68
    v_dot2c_f32_bf16 v83, s60, v69
    v_dot2c_f32_bf16 v83, s60, v70
    v_dot2c_f32_bf16 v83, s60, v71
    s_lshl_b32 s64, s59, 10
    s_sub_u32 s65, s79, s64
    s_add_u32 s64, s79, s64
    s_add_u32 s65, s65, 5120
    v_add_u32 v247, s65, v8
    v_add_u32 v8, s64, v8
    v_permlane32_swap_b32 v82, v83
    v_add_f32 v82, v82, v83
    s_waitcnt lgkmcnt(4)
    v_dot2c_f32_bf16 v80, s60, v144
    v_dot2c_f32_bf16 v81, v144, v144
    v_dot2c_f32_bf16 v80, s60, v145
    v_dot2c_f32_bf16 v81, v145, v145
    v_dot2c_f32_bf16 v80, s60, v146
    v_dot2c_f32_bf16 v81, v146, v146
    v_dot2c_f32_bf16 v80, s60, v147
    v_dot2c_f32_bf16 v81, v147, v147
    s_waitcnt lgkmcnt(3)
    v_dot2c_f32_bf16 v80, s60, v148
    v_dot2c_f32_bf16 v81, v148, v148
    v_dot2c_f32_bf16 v80, s60, v149
    v_dot2c_f32_bf16 v81, v149, v149
    v_dot2c_f32_bf16 v80, s60, v150
    v_dot2c_f32_bf16 v81, v150, v150
    v_dot2c_f32_bf16 v80, s60, v151
    v_dot2c_f32_bf16 v81, v151, v151
    s_waitcnt lgkmcnt(2)
    v_dot2c_f32_bf16 v80, s60, v152
    v_dot2c_f32_bf16 v81, v152, v152
    v_dot2c_f32_bf16 v80, s60, v153
    v_dot2c_f32_bf16 v81, v153, v153
    v_dot2c_f32_bf16 v80, s60, v154
    v_dot2c_f32_bf16 v81, v154, v154
    v_dot2c_f32_bf16 v80, s60, v155
    v_dot2c_f32_bf16 v81, v155, v155
    s_waitcnt lgkmcnt(1)
    v_dot2c_f32_bf16 v80, s60, v156
    v_dot2c_f32_bf16 v81, v156, v156
    v_dot2c_f32_bf16 v80, s60, v157
    v_dot2c_f32_bf16 v81, v157, v157
    v_dot2c_f32_bf16 v80, s60, v158
    v_dot2c_f32_bf16 v81, v158, v158
    v_dot2c_f32_bf16 v80, s60, v159
    v_dot2c_f32_bf16 v81, v159, v159
    s_waitcnt lgkmcnt(0)
    v_dot2c_f32_bf16 v80, s60, v160
    v_dot2c_f32_bf16 v81, v160, v160
    v_dot2c_f32_bf16 v80, s60, v161
    v_dot2c_f32_bf16 v81, v161, v161
    v_dot2c_f32_bf16 v80, s60, v162
    v_dot2c_f32_bf16 v81, v162, v162
    v_dot2c_f32_bf16 v80, s60, v163
    v_dot2c_f32_bf16 v81, v163, v163
    s_bitcmp1_b32 s52, 0
    s_cbranch_scc1 L_kv_v
    v_mfma_f32_16x16x32_bf16 v[72:75], v[32:35], v[144:147], 0
    v_mfma_f32_16x16x32_bf16 v[76:79], v[36:39], v[144:147], 0
    v_mfma_f32_16x16x32_bf16 v[72:75], v[40:43], v[148:151], v[72:75]
    v_mfma_f32_16x16x32_bf16 v[76:79], v[44:47], v[148:151], v[76:79]
    v_mfma_f32_16x16x32_bf16 v[72:75], v[48:51], v[152:155], v[72:75]
    v_mfma_f32_16x16x32_bf16 v[76:79], v[52:55], v[152:155], v[76:79]
    v_mfma_f32_16x16x32_bf16 v[72:75], v[56:59], v[156:159], v[72:75]
    v_mfma_f32_16x16x32_bf16 v[76:79], v[60:63], v[156:159], v[76:79]
    v_mfma_f32_16x16x32_bf16 v[72:75], v[64:67], v[160:163], v[72:75]
    v_mfma_f32_16x16x32_bf16 v[76:79], v[68:71], v[160:163], v[76:79]
    s_branch L_kv_j
L_kv_v:
    v_mfma_f32_16x16x32_bf16 v[72:75], v[144:147], v[32:35], 0
    v_mfma_f32_16x16x32_bf16 v[76:79], v[144:147], v[36:39], 0
    v_mfma_f32_16x16x32_bf16 v[72:75], v[148:151], v[40:43], v[72:75]
    v_mfma_f32_16x16x32_bf16 v[76:79], v[148:151], v[44:47], v[76:79]
    v_mfma_f32_16x16x32_bf16 v[72:75], v[152:155], v[48:51], v[72:75]
    v_mfma_f32_16x16x32_bf16 v[76:79], v[152:155], v[52:55], v[76:79]
    v_mfma_f32_16x16x32_bf16 v[72:75], v[156:159], v[56:59], v[72:75]
    v_mfma_f32_16x16x32_bf16 v[76:79], v[156:159], v[60:63], v[76:79]
    v_mfma_f32_16x16x32_bf16 v[72:75], v[160:163], v[64:67], v[72:75]
    v_mfma_f32_16x16x32_bf16 v[76:79], v[160:163], v[68:71], v[76:79]
L_kv_j:
    v_permlane32_swap_b32 v80, v81
    v_add_f32 v80, v80, v81
    s_nop 1
    v_permlane16_swap_b32 v80, v82
    v_add_f32 v80, v80, v82
    ds_write_b32 v242, v80
    s_nop 0
    ds_write_b128 v87, v[72:75]
    ds_write_b128 v87, v[76:79] offset:1024
    s_mov_b64 exec, 1
    ds_add_u32 v240, v241 offset:4
    s_mov_b64 exec, -1
    s_cmp_lg_u32 s48, 0
    s_cbranch_scc1 L_lo_pre
L_fin:
    v_lshrrev_b32 v9, 4, v1
    v_lshlrev_b32 v11, 4, v9
    v_add_u32 v11, 157696, v11
    v_lshlrev_b32 v84, 2, v6
    v_add_u32 v84, 157696, v84
    s_lshl_b32 s64, s51, 2
    s_add_u32 s64, s64, s68
L_cnt:
    ds_read_b32 v241, v240 offset:4
    s_waitcnt lgkmcnt(0)
    v_readfirstlane_b32 s65, v241
    s_sub_u32 s62, s62, 1
    s_cbranch_scc1 L_cnt_x
    s_cmp_lt_u32 s65, 4
    s_cbranch_scc1 L_cnt
L_cnt_x:
    ds_read2st64_b32 v[144:145], v242 offset0:1 offset1:2
    ds_read_b32 v146, v242 offset:768
    ds_read_b128 v[40:43], v87 offset:2048
    ds_read_b128 v[44:47], v87 offset:3072
    ds_read_b128 v[48:51], v87 offset:4096
    ds_read_b128 v[52:55], v87 offset:5120
    ds_read_b128 v[56:59], v87 offset:6144
    ds_read_b128 v[60:63], v87 offset:7168
    s_mov_b32 s62, 200000
    s_waitcnt lgkmcnt(6)
    v_add_f32 v144, v144, v145
    v_add_f32 v146, v146, v80
    v_add_f32 v144, v144, v146
    v_add_f32 v145, v144, 0
    v_add_f32 v146, v144, 0
    ds_write_b32 v242, v144
    s_nop 0
    v_permlane32_swap_b32 v145, v146
    v_mul_f32 v145, s27, v145
    v_mul_f32 v146, s27, v146
    v_fma_f32 v146, -v145, v145, v146
    v_max_f32 v146, 0, v146
    v_add_f32 v146, s32, v146
    v_rsq_f32 v146, v146
    s_nop 0
    ds_write2st64_b32 v242, v145, v146 offset0:1 offset1:2
    s_bitcmp1_b32 s52, 0
    s_cbranch_scc1 L_fin_v
    ds_read2st64_b32 v[164:165], v84 offset0:1 offset1:2
    ds_read_b128 v[168:171], v11 offset:64
    ds_read_b128 v[172:175], v11 offset:192
    v_lshlrev_b32 v10, 3, v9
    v_lshl_add_u32 v10, v6, 5, v10
    v_lshlrev_b32 v11, 9, v9
    v_lshl_add_u32 v11, v6, 4, v11
    s_lshl_b32 s67, s64, 9
    s_add_u32 s67, s67, 65536
    s_lshl_b32 s65, s51, 10
    s_and_b32 s66, s64, 1
    s_lshl_b32 s66, s66, 8
    s_add_u32 s65, s65, s66
    s_and_b32 s66, s64, 2
    s_lshl_b32 s66, s66, 2
    s_add_u32 s65, s65, s66
    s_add_u32 s65, s65, 131072
    s_waitcnt lgkmcnt(5)
    v_add_f32 v32, v72, v40
    v_add_f32 v48, v48, v56
    v_add_f32 v33, v73, v41
    v_add_f32 v49, v49, v57
    v_add_f32 v34, v74, v42
    v_add_f32 v50, v50, v58
    v_add_f32 v35, v75, v43
    v_add_f32 v51, v51, v59
    v_add_f32 v36, v76, v44
    v_add_f32 v52, v52, v60
    v_add_f32 v37, v77, v45
    v_add_f32 v53, v53, v61
    v_add_f32 v38, v78, v46
    v_add_f32 v54, v54, v62
    v_add_f32 v39, v79, v47
    v_add_f32 v55, v55, v63
    v_add_f32 v32, v32, v48
    v_add_f32 v33, v33, v49
    v_add_f32 v34, v34, v50
    v_add_f32 v35, v35, v51
    v_add_f32 v36, v36, v52
    v_add_f32 v37, v37, v53
    v_add_f32 v38, v38, v54
    v_add_f32 v39, v39, v55
    s_waitcnt lgkmcnt(0)
    v_fma_f32 v32, -v164, v168, v32
    v_fma_f32 v33, -v164, v169, v33
    v_fma_f32 v34, -v164, v170, v34
    v_fma_f32 v35, -v164, v171, v35
    v_fma_f32 v36, -v164, v172, v36
    v_fma_f32 v37, -v164, v173, v37
    v_fma_f32 v38, -v164, v174, v38
    v_fma_f32 v39, -v164, v175, v39
    v_mul_f32 v32, v165, v32
    v_mul_f32 v33, v165, v33
    v_mul_f32 v34, v165, v34
    v_mul_f32 v35, v165, v35
    v_mul_f32 v36, v165, v36
    v_mul_f32 v37, v165, v37
    v_mul_f32 v38, v165, v38
    v_mul_f32 v39, v165, v39
    v_cvt_pk_bf16_f32 v176, v32, v33
    v_cvt_pk_bf16_f32 v177, v34, v35
    v_cvt_pk_bf16_f32 v178, v36, v37
    v_cvt_pk_bf16_f32 v179, v38, v39
    buffer_store_dwordx2 v[176:177], v10, s[12:15], s67 offen sc1
    s_mov_b32 exec_lo, 0xffff0000
    s_mov_b32 exec_hi, 0
    v_mov_b32 v178, s60
    v_mov_b32 v179, 0x3f80
    s_mov_b32 exec_lo, -1
    buffer_store_dwordx2 v[178:179], v11, s[12:15], s65 offen sc1
    s_branch L_fin_f
L_fin_v:
    ds_read_b128 v[164:167], v11 offset:256
    ds_read_b128 v[168:171], v11 offset:512
    ds_read2_b32 v[172:173], v84 offset0:16 offset1:48
    v_and_b32 v10, 1, v9
    v_mul_u32_u24 v10, 336, v10
    v_lshl_add_u32 v10, v6, 4, v10
    v_lshrrev_b32 v11, 5, v1
    v_lshl_add_u32 v10, v11, 3, v10
    s_mul_i32 s65, s64, 672
    s_add_u32 s65, s65, 196608
    s_waitcnt lgkmcnt(5)
    v_add_f32 v32, v72, v40
    v_add_f32 v48, v48, v56
    v_add_f32 v33, v73, v41
    v_add_f32 v49, v49, v57
    v_add_f32 v34, v74, v42
    v_add_f32 v50, v50, v58
    v_add_f32 v35, v75, v43
    v_add_f32 v51, v51, v59
    v_add_f32 v36, v76, v44
    v_add_f32 v52, v52, v60
    v_add_f32 v37, v77, v45
    v_add_f32 v53, v53, v61
    v_add_f32 v38, v78, v46
    v_add_f32 v54, v54, v62
    v_add_f32 v39, v79, v47
    v_add_f32 v55, v55, v63
    v_add_f32 v32, v32, v48
    v_add_f32 v33, v33, v49
    v_add_f32 v34, v34, v50
    v_add_f32 v35, v35, v51
    v_add_f32 v36, v36, v52
    v_add_f32 v37, v37, v53
    v_add_f32 v38, v38, v54
    v_add_f32 v39, v39, v55
    s_waitcnt lgkmcnt(0)
    v_fma_f32 v32, -v164, v172, v32
    v_fma_f32 v33, -v165, v172, v33
    v_fma_f32 v34, -v166, v172, v34
    v_fma_f32 v35, -v167, v172, v35
    v_fma_f32 v36, -v164, v173, v36
    v_fma_f32 v37, -v165, v173, v37
    v_fma_f32 v38, -v166, v173, v38
    v_fma_f32 v39, -v167, v173, v39
    v_mul_f32 v32, v168, v32
    v_mul_f32 v33, v169, v33
    v_mul_f32 v34, v170, v34
    v_mul_f32 v35, v171, v35
    v_mul_f32 v36, v168, v36
    v_mul_f32 v37, v169, v37
    v_mul_f32 v38, v170, v38
    v_mul_f32 v39, v171, v39
    v_cvt_pk_bf16_f32 v176, v32, v33
    v_cvt_pk_bf16_f32 v177, v34, v35
    v_cvt_pk_bf16_f32 v178, v36, v37
    v_cvt_pk_bf16_f32 v179, v38, v39
    buffer_store_dwordx2 v[176:177], v10, s[12:15], s65 offen sc1
    s_mov_b32 exec_lo, 0x00100010
    s_mov_b32 exec_hi, 0x00100010
    v_mov_b32 v178, s60
    v_mov_b32 v179, s60
    s_mov_b32 exec_lo, 0x001f001f
    s_mov_b32 exec_hi, 0x001f001f
    buffer_store_dwordx2 v[178:179], v10, s[12:15], s65 offen offset:256 sc1
L_fin_f:
    s_mov_b64 exec, -1
    s_waitcnt vmcnt(2)
    v_readfirstlane_b32 s54, v243
    s_nop 0
    s_mul_i32 s54, s54, 0x2c9277b5
    s_add_u32 s54, s54, 0xac564b05
    v_mov_b32 v241, s54
    ds_write_b32 v240, v241 offset:8
L_lo_pre:
    s_barrier
    ds_read_b128 v[192:195], v8 offset:0
    ds_read_b128 v[196:199], v8 offset:1024
    ds_read_b128 v[200:203], v8 offset:2048
    ds_read_b128 v[204:207], v8 offset:3072
    ds_read_b128 v[208:211], v8 offset:4096
    ds_read_b128 v[212:215], v247 offset:0
    ds_read_b128 v[216:219], v247 offset:1024
    ds_read_b128 v[220:223], v247 offset:2048
    ds_read_b128 v[224:227], v247 offset:3072
    ds_read_b128 v[228:231], v247 offset:4096
    ds_read_b64 v[236:237], v244
    ds_read_b64 v[238:239], v245
    ds_read_b64 v[254:255], v246
    s_cmp_ge_u32 s2, 232
    s_cselect_b32 s64, 232, 0
    s_sub_u32 s20, s2, s64
    s_mul_i32 s20, s20, 5
    s_min_u32 s69, s48, 4
    s_add_u32 s69, s69, s20
    s_mov_b32 s38, 1966080
    s_mov_b32 s39, 0x20000
    s_cmp_ge_u32 s69, 480
    s_cbranch_scc1 L_h1c_1
    s_mov_b32 s36, s28
    s_mov_b32 s37, s29
    s_mul_hi_u32 s64, s69, 0x0ccccccd
    s_mul_i32 s65, s64, 20
    s_sub_u32 s65, s69, s65
    s_cmp_ge_u32 s65, 10
    s_cselect_b32 s66, 320, 0
    s_cselect_b32 s67, 10, 0
    s_sub_u32 s65, s65, s67
    s_lshr_b32 s67, s65, 1
    s_mul_i32 s67, s67, 80
    s_and_b32 s28, s65, 1
    s_lshl_b32 s28, s28, 5
    s_add_u32 s67, s67, s28
    s_mul_i32 s28, s65, 160
    s_sub_u32 s28, s28, 1216
    s_cmp_lt_u32 s65, 8
    s_cselect_b32 s67, s67, s28
    s_cselect_b32 s31, 16, 80
    s_add_u32 s66, s66, s67
    s_movk_i32 s28, 3072
    s_mov_b32 s29, 4
    s_mov_b32 s30, 8
    s_branch L_h1d_3
L_h1c_1:
    s_sub_u32 s69, s69, 480
    s_mul_hi_u32 s65, s69, 0x1999999a
    s_mul_i32 s64, s65, 10
    s_sub_u32 s64, s69, s64
    s_movk_i32 s28, 1280
    s_cmp_ge_u32 s65, 48
    s_cbranch_scc1 L_h1o_2
    s_mov_b32 s36, s30
    s_mov_b32 s37, s31
    s_mul_hi_u32 s66, s65, 0x2aaaaaab
    s_mul_i32 s67, s66, 6
    s_sub_u32 s65, s65, s67
    s_mul_i32 s66, s66, 192
    s_mul_i32 s67, s65, 48
    s_mul_i32 s29, s65, 96
    s_sub_u32 s29, s29, 352
    s_cmp_lt_u32 s65, 4
    s_cselect_b32 s67, s67, s29
    s_cselect_b32 s31, 16, 48
    s_add_u32 s66, s66, s67
    s_mov_b32 s29, 4
    s_mov_b32 s30, 8
    s_branch L_h1d_3
L_h1o_2:
    s_mov_b32 s36, s40
    s_mov_b32 s37, s41
    s_mov_b32 s38, 819200
    s_sub_u32 s65, s65, 48
    s_cmp_ge_u32 s65, 10
    s_cselect_b32 s66, 320, 0
    s_cselect_b32 s67, 10, 0
    s_sub_u32 s65, s65, s67
    s_mul_i32 s67, s65, 40
    s_mul_i32 s29, s65, 160
    s_sub_u32 s29, s29, 1264
    s_cmp_lt_u32 s65, 8
    s_cselect_b32 s67, s67, s29
    s_cselect_b32 s29, 4, 20
    s_cselect_b32 s30, 20, 40
    s_cselect_b32 s31, 8, 80
    s_add_u32 s66, s66, s67
L_h1d_3:
    s_mul_i32 s82, s66, s28
    s_lshl_b32 s67, s64, 7
    s_add_u32 s82, s82, s67
    v_lshrrev_b32 v18, 5, v1
    v_mul_u32_u24 v18, s29, v18
    v_bfe_u32 v19, v1, 3, 2
    v_add_u32 v18, v18, v19
    v_mul_u32_u24 v18, s28, v18
    v_and_b32 v19, 7, v1
    v_lshl_add_u32 v18, v19, 4, v18
    s_mul_i32 s30, s30, s28
    s_sub_u32 s30, s30, 1024
    s_mul_i32 s31, s31, s28
    s_sub_u32 s31, s31, 2048
    v_add_u32 v19, s30, v18
    v_add_u32 v20, s31, v18
    v_add_u32 v21, s30, v20
    s_waitcnt lgkmcnt(0)
    v_mfma_f32_16x16x32_bf16 v[112:115], v[248:251], v[192:195], 0
    v_and_b32 v28, 31, v1
    s_lshl_b32 s64, s48, 7
    v_lshl_add_u32 v28, v28, 2, s64
    s_lshl_b32 s34, s48, 12
    s_add_u32 s34, s34, 131072
    v_mfma_f32_16x16x32_bf16 v[116:119], v[192:195], v[192:195], 0
    s_lshl_b32 s3, s48, 13
    s_add_u32 s3, s3, 65536
    s_mul_i32 s35, s48, 10752
    s_add_u32 s35, s35, 196608
    s_mul_i32 s69, s49, 20480
    v_mfma_f32_16x16x32_bf16 v[112:115], v[248:251], v[196:199], v[112:115]
    s_add_u32 s16, s79, s55
    s_add_u32 s33, s16, 4096
    s_add_u32 s78, s16, 8192
    s_lshr_b32 s64, s52, 2
    s_mul_i32 s64, s64, 10240
    v_mfma_f32_16x16x32_bf16 v[116:119], v[196:199], v[196:199], v[116:119]
    s_add_u32 s64, s64, s55
    s_and_b32 s65, s52, 3
    s_lshl_b32 s66, s65, 11
    s_add_u32 s66, s66, s64
    v_mfma_f32_16x16x32_bf16 v[112:115], v[248:251], v[200:203], v[112:115]
    s_lshr_b32 s67, s65, 1
    s_lshl_b32 s67, s67, 10
    s_add_u32 s67, s67, s64
    s_and_b32 s65, s65, 1
    s_lshl_b32 s65, s65, 3
    v_mfma_f32_16x16x32_bf16 v[116:119], v[200:203], v[200:203], v[116:119]
    s_add_u32 s67, s67, s65
    s_add_u32 s67, s67, 8192
    s_mul_i32 s64, s50, 40960
    s_lshl_b32 s65, s49, 9
    s_add_u32 s56, s66, s64
    v_mfma_f32_16x16x32_bf16 v[112:115], v[248:251], v[204:207], v[112:115]
    s_add_u32 s56, s56, s65
    s_lshl_b32 s65, s49, 8
    s_add_u32 s57, s67, s64
    s_add_u32 s57, s57, s65
    v_mfma_f32_16x16x32_bf16 v[116:119], v[204:207], v[204:207], v[116:119]
    s_add_u32 s69, s69, 81920
    s_lshl_b32 s65, s50, 10
    s_add_u32 s17, s66, s69
    s_add_u32 s17, s17, s65
    s_add_u32 s18, s67, s69
    v_mfma_f32_16x16x32_bf16 v[112:115], v[248:251], v[208:211], v[112:115]
    s_lshl_b32 s64, s52, 2
    s_add_u32 s64, s64, s50
    s_mul_i32 s64, s64, 6144
    s_add_u32 s64, s64, s55
    s_add_u32 s64, s64, 163840
    v_mfma_f32_16x16x32_bf16 v[116:119], v[208:211], v[208:211], v[116:119]
    s_lshl_b32 s65, s49, 10
    s_add_u32 s19, s64, s65
    s_lshr_b32 s65, s49, 1
    s_lshl_b32 s65, s65, 10
    v_mfma_f32_16x16x32_bf16 v[112:115], v[248:251], v[212:215], v[112:115]
    s_add_u32 s24, s64, s65
    s_and_b32 s65, s49, 1
    s_lshl_b32 s65, s65, 3
    s_add_u32 s24, s24, s65
    s_add_u32 s24, s24, 4096
    v_mfma_f32_16x16x32_bf16 v[116:119], v[212:215], v[212:215], v[116:119]
    s_mul_i32 s25, s48, 24576
    s_add_u32 s25, s25, s55
    s_add_u32 s25, s25, 163840
    s_add_u32 s26, s26, s53
    s_mul_i32 s64, s52, 12
    v_mfma_f32_16x16x32_bf16 v[112:115], v[248:251], v[216:219], v[112:115]
    s_mul_i32 s65, s49, 3
    s_add_u32 s64, s64, s65
    s_mul_i32 s67, s50, 40960
    s_add_u32 s67, s67, 2097152
    s_lshr_b32 s65, s64, 2
    v_mfma_f32_16x16x32_bf16 v[116:119], v[216:219], v[216:219], v[116:119]
    s_mul_i32 s65, s65, 77824
    s_lshl_b32 s66, s64, 10
    s_add_u32 s65, s65, s66
    s_add_u32 s73, s65, s67
    v_mfma_f32_16x16x32_bf16 v[112:115], v[248:251], v[220:223], v[112:115]
    s_add_u32 s64, s64, 1
    s_lshr_b32 s65, s64, 2
    s_mul_i32 s65, s65, 77824
    s_lshl_b32 s66, s64, 10
    s_add_u32 s65, s65, s66
    v_mfma_f32_16x16x32_bf16 v[116:119], v[220:223], v[220:223], v[116:119]
    s_add_u32 s74, s65, s67
    s_add_u32 s64, s64, 1
    s_lshr_b32 s65, s64, 2
    s_mul_i32 s65, s65, 77824
    s_lshl_b32 s66, s64, 10
    v_mfma_f32_16x16x32_bf16 v[112:115], v[248:251], v[224:227], v[112:115]
    s_add_u32 s65, s65, s66
    s_add_u32 s21, s65, s67
    s_mul_i32 s64, s48, 245760
    s_mul_i32 s65, s52, 5120
    v_mfma_f32_16x16x32_bf16 v[116:119], v[224:227], v[224:227], v[116:119]
    s_add_u32 s64, s64, s65
    s_add_u32 s42, s64, 4063232
    s_lshl_b32 s77, s50, 1
    s_add_u32 s77, s77, s49
    s_and_b32 s77, s77, 3
    v_mfma_f32_16x16x32_bf16 v[112:115], v[248:251], v[228:231], v[112:115]
    v_and_b32 v9, 31, v1
    v_lshrrev_b32 v10, 5, v1
    v_lshlrev_b32 v142, 4, v10
    v_lshl_add_u32 v142, v9, 5, v142
    v_mul_u32_u24 v143, 336, v10
    v_mfma_f32_16x16x32_bf16 v[116:119], v[228:231], v[228:231], v[116:119]
    v_lshl_add_u32 v143, v9, 4, v143
    v_add_u32 v9, 11, v9
    v_and_b32 v9, 32, v9
    v_lshl_add_u32 v143, v9, 23, v143
    s_cmp_lg_u32 s48, 0
    s_cbranch_scc1 L_bx
    s_lshl_b32 s65, s51, 3
    s_add_u32 s65, s65, s52
    s_lshl_b32 s65, s65, 2
    s_add_u32 s65, s65, 4096
    v_mov_b32 v29, 0
    v_mov_b32 v241, s54
    s_waitcnt vmcnt(0)
    s_mov_b64 exec, 1
    buffer_store_dword v241, v29, s[12:15], s65 offen sc1
    s_mov_b64 exec, -1
    s_branch L_bx
L_hi:
    v_mov_b32 v7, 158848
    v_mov_b32 v132, 0
    v_mov_b32 v133, 0
    ds_write_b64 v7, v[132:133]
    s_movk_i32 s69, 1280
    v_add_u32 v9, 0, v1
    v_mul_u32_u24 v10, 0xcccd, v9
    v_lshrrev_b32 v10, 19, v10
    v_mul_u32_u24 v11, 10, v10
    v_sub_u32 v9, v9, v11
    v_lshlrev_b32 v9, 4, v9
    v_subrev_u32 v9, 0, v9
    v_lshrrev_b32 v11, 1, v10
    v_and_b32 v11, 4, v11
    v_xor_b32 v10, v10, v11
    v_mad_u32_u24 v12, v10, s69, v9
    v_add_u32 v9, 64, v1
    v_mul_u32_u24 v10, 0xcccd, v9
    v_lshrrev_b32 v10, 19, v10
    v_mul_u32_u24 v11, 10, v10
    v_sub_u32 v9, v9, v11
    v_lshlrev_b32 v9, 4, v9
    v_subrev_u32 v9, 1024, v9
    v_lshrrev_b32 v11, 1, v10
    v_and_b32 v11, 4, v11
    v_xor_b32 v10, v10, v11
    v_mad_u32_u24 v13, v10, s69, v9
    v_add_u32 v9, 128, v1
    v_mul_u32_u24 v10, 0xcccd, v9
    v_lshrrev_b32 v10, 19, v10
    v_mul_u32_u24 v11, 10, v10
    v_sub_u32 v9, v9, v11
    v_lshlrev_b32 v9, 4, v9
    v_subrev_u32 v9, 2048, v9
    v_lshrrev_b32 v11, 1, v10
    v_and_b32 v11, 4, v11
    v_xor_b32 v10, v10, v11
    v_mad_u32_u24 v14, v10, s69, v9
    v_add_u32 v9, 192, v1
    v_mul_u32_u24 v10, 0xcccd, v9
    v_lshrrev_b32 v10, 19, v10
    v_mul_u32_u24 v11, 10, v10
    v_sub_u32 v9, v9, v11
    v_lshlrev_b32 v9, 4, v9
    v_subrev_u32 v9, 3072, v9
    v_lshrrev_b32 v11, 1, v10
    v_and_b32 v11, 4, v11
    v_xor_b32 v10, v10, v11
    v_mad_u32_u24 v15, v10, s69, v9
    v_add_u32 v9, 256, v1
    v_mul_u32_u24 v10, 0xcccd, v9
    v_lshrrev_b32 v10, 19, v10
    v_mul_u32_u24 v11, 10, v10
    v_sub_u32 v9, v9, v11
    v_lshlrev_b32 v9, 4, v9
    v_subrev_u32 v9, 0, v9
    v_lshrrev_b32 v11, 1, v10
    v_and_b32 v11, 4, v11
    v_xor_b32 v10, v10, v11
    v_mad_u32_u24 v16, v10, s69, v9
    v_lshlrev_b32 v11, 2, v1
    v_add_u32 v11, 158976, v11
    ds_write2st64_b32 v11, v12, v13 offset0:0 offset1:1
    ds_write2st64_b32 v11, v14, v15 offset0:2 offset1:3
    ds_write_b32 v11, v16 offset:1024
    s_waitcnt lgkmcnt(0)
    s_barrier
    s_add_u32 s68, s68, 1
    s_and_b32 s68, s68, 3
    s_mul_i32 s76, s68, 20480
    s_add_u32 s58, s72, s76
    s_add_u32 s76, s76, s75
    s_add_u32 m0, s76, 0
    s_nop 0
    buffer_load_dwordx4 v30, s[4:7], s58 offen offset:0 lds
    s_add_u32 m0, s76, 960
    s_nop 0
    buffer_load_dwordx4 v30, s[4:7], s58 offen offset:64 lds
    s_mov_b32 s10, 819200
    s_mov_b32 s11, 0x20000
    s_mov_b32 s14, 67108864
    s_mov_b32 s15, 0x20000
    s_mov_b32 s46, 2621440
    s_mov_b32 s47, 0x20000
    s_mul_i32 s53, s52, 160
    s_lshl_b32 s55, s51, 19
    s_add_u32 s55, s55, 8388608
    s_mov_b32 s60, 0x3f803f80
    s_and_b32 s59, s51, 1
    s_add_u32 m0, s76, 1920
    s_nop 0
    buffer_load_dwordx4 v30, s[4:7], s58 offen offset:128 lds
    s_mul_i32 s59, s59, 5
    s_mov_b32 s61, 0
    s_mov_b32 s63, 0
    s_mov_b32 s27, 986500301
    s_mov_b32 s32, 925353388
    s_mov_b32 s62, 200000
    v_bfe_u32 v6, v1, 4, 1
    v_mul_u32_u24 v5, 20480, v6
    v_lshlrev_b32 v244, 3, v6
    v_and_b32 v6, 15, v1
    s_add_u32 m0, s76, 2880
    s_nop 0
    buffer_load_dwordx4 v30, s[4:7], s58 offen offset:192 lds
    v_lshl_add_u32 v5, v6, 4, v5
    v_lshrrev_b32 v7, 5, v1
    v_lshl_add_u32 v5, v7, 8, v5
    v_bfe_u32 v11, v1, 2, 2
    v_sub_u32 v9, 0, v11
    v_xor_b32 v7, v7, v9
    v_and_b32 v7, 3, v7
    v_lshl_add_u32 v244, v7, 4, v244
    v_lshl_add_u32 v244, v6, 6, v244
    v_lshrrev_b32 v10, 4, v1
    v_xor_b32 v9, v9, v10
    s_add_u32 m0, s76, 3840
    s_nop 0
    buffer_load_dwordx4 v30, s[4:7], s58 offen offset:256 lds
    v_and_b32 v9, 3, v9
    v_lshlrev_b32 v9, 4, v9
    v_lshl_add_u32 v8, v6, 6, v9
    v_lshl_add_u32 v7, v10, 3, v11
    v_and_b32 v9, 1, v10
    v_lshl_add_u32 v3, v9, 2, v7
    v_xor_b32 v4, 4, v3
    v_and_b32 v9, 3, v1
    v_lshlrev_b32 v9, 3, v9
    s_mul_i32 s69, s50, 5120
    s_add_u32 s68, s68, 1
    s_and_b32 s68, s68, 3
    s_add_u32 s69, s69, 81920
    v_add_u32 v9, s69, v9
    s_movk_i32 s69, 160
    v_mad_u32_u24 v3, v3, s69, v9
    v_mad_u32_u24 v4, v4, s69, v9
    s_lshr_b32 s64, s49, 1
    s_mul_i32 s64, s64, 5120
    s_mul_i32 s65, s50, 3072
    s_add_u32 s64, s64, s65
    s_and_b32 s65, s49, 1
    s_mul_i32 s76, s68, 20480
    s_add_u32 s58, s72, s76
    s_add_u32 s76, s76, s75
    s_lshl_b32 s65, s65, 7
    s_add_u32 s64, s64, s65
    s_add_u32 s64, s64, 102400
    v_lshlrev_b32 v27, 8, v10
    v_lshl_add_u32 v27, v6, 3, v27
    v_add_u32 v27, s64, v27
    s_mul_i32 s69, s49, 20480
    s_mul_i32 s65, s50, 10240
    s_add_u32 s79, s69, s65
    s_mul_i32 s64, s52, 5
    s_add_u32 s65, s64, 4
    s_add_u32 m0, s76, 0
    s_nop 0
    buffer_load_dwordx4 v30, s[4:7], s58 offen offset:0 lds
    s_and_b32 s66, s65, 1
    s_lshl_b32 s66, s66, 5
    s_lshr_b32 s65, s65, 1
    s_lshl_b32 s65, s65, 10
    s_add_u32 s65, s65, s69
    v_xor_b32 v246, s66, v244
    v_add_u32 v246, s65, v246
    s_lshl_b32 s65, s50, 1
    s_add_u32 s65, s65, s64
    s_add_u32 s65, s65, 1
    s_add_u32 m0, s76, 960
    s_nop 0
    buffer_load_dwordx4 v30, s[4:7], s58 offen offset:64 lds
    s_and_b32 s66, s65, 1
    s_lshl_b32 s66, s66, 5
    s_lshr_b32 s65, s65, 1
    s_lshl_b32 s65, s65, 10
    s_add_u32 s65, s65, s69
    v_xor_b32 v245, s66, v244
    v_add_u32 v245, s65, v245
    s_lshl_b32 s65, s50, 1
    s_add_u32 s65, s65, s64
    s_and_b32 s66, s65, 1
    s_lshl_b32 s66, s66, 5
    s_add_u32 m0, s76, 1920
    s_nop 0
    buffer_load_dwordx4 v30, s[4:7], s58 offen offset:128 lds
    s_lshr_b32 s65, s65, 1
    s_lshl_b32 s65, s65, 10
    s_add_u32 s65, s65, s69
    v_xor_b32 v244, s66, v244
    v_add_u32 v244, s65, v244
    v_mov_b32 v248, s60
    v_mov_b32 v249, s60
    v_mov_b32 v250, s60
    v_mov_b32 v251, s60
    v_and_b32 v28, 31, v1
    s_add_u32 m0, s76, 2880
    s_nop 0
    buffer_load_dwordx4 v30, s[4:7], s58 offen offset:192 lds
    s_lshl_b32 s64, s48, 7
    v_lshl_add_u32 v28, v28, 2, s64
    s_lshl_b32 s34, s48, 12
    s_add_u32 s34, s34, 131072
    s_lshl_b32 s3, s48, 13
    s_add_u32 s3, s3, 65536
    s_mul_i32 s35, s48, 10752
    s_add_u32 s35, s35, 196608
    s_mul_i32 s69, s49, 20480
    s_add_u32 s16, s79, s55
    s_add_u32 m0, s76, 3840
    s_nop 0
    buffer_load_dwordx4 v30, s[4:7], s58 offen offset:256 lds
    s_add_u32 s33, s16, 4096
    s_add_u32 s78, s16, 8192
    s_lshr_b32 s64, s52, 2
    s_mul_i32 s64, s64, 10240
    s_add_u32 s64, s64, s55
    s_and_b32 s65, s52, 3
    s_lshl_b32 s66, s65, 11
    s_add_u32 s66, s66, s64
    s_lshr_b32 s67, s65, 1
    s_lshl_b32 s67, s67, 10
    s_add_u32 s67, s67, s64
    s_add_u32 s68, s68, 1
    s_and_b32 s68, s68, 3
    s_and_b32 s65, s65, 1
    s_lshl_b32 s65, s65, 3
    s_add_u32 s67, s67, s65
    s_add_u32 s67, s67, 8192
    s_mul_i32 s64, s50, 40960
    s_lshl_b32 s65, s49, 9
    s_add_u32 s56, s66, s64
    s_add_u32 s56, s56, s65
    s_lshl_b32 s65, s49, 8
    s_add_u32 s57, s67, s64
    s_mul_i32 s76, s68, 20480
    s_add_u32 s58, s72, s76
    s_add_u32 s76, s76, s75
    s_add_u32 s57, s57, s65
    s_add_u32 s69, s69, 81920
    s_lshl_b32 s65, s50, 10
    s_add_u32 s17, s66, s69
    s_add_u32 s17, s17, s65
    s_add_u32 s18, s67, s69
    s_lshl_b32 s64, s52, 2
    s_add_u32 s64, s64, s50
    s_mul_i32 s64, s64, 6144
    s_add_u32 s64, s64, s55
    s_add_u32 s64, s64, 163840
    s_add_u32 m0, s76, 0
    s_nop 0
    buffer_load_dwordx4 v30, s[4:7], s58 offen offset:0 lds
    s_lshl_b32 s65, s49, 10
    s_add_u32 s19, s64, s65
    s_lshr_b32 s65, s49, 1
    s_lshl_b32 s65, s65, 10
    s_add_u32 s24, s64, s65
    s_and_b32 s65, s49, 1
    s_lshl_b32 s65, s65, 3
    s_add_u32 s24, s24, s65
    s_add_u32 s24, s24, 4096
    s_mul_i32 s25, s48, 24576
    s_add_u32 m0, s76, 960
    s_nop 0
    buffer_load_dwordx4 v30, s[4:7], s58 offen offset:64 lds
    s_add_u32 s25, s25, s55
    s_add_u32 s25, s25, 163840
    s_add_u32 s26, s26, s53
    s_mul_i32 s64, s52, 12
    s_mul_i32 s65, s49, 3
    s_add_u32 s64, s64, s65
    s_mul_i32 s67, s50, 40960
    s_add_u32 s67, s67, 2097152
    s_lshr_b32 s65, s64, 2
    s_mul_i32 s65, s65, 77824
    s_add_u32 m0, s76, 1920
    s_nop 0
    buffer_load_dwordx4 v30, s[4:7], s58 offen offset:128 lds
    s_lshl_b32 s66, s64, 10
    s_add_u32 s65, s65, s66
    s_add_u32 s73, s65, s67
    s_add_u32 s64, s64, 1
    s_lshr_b32 s65, s64, 2
    s_mul_i32 s65, s65, 77824
    s_lshl_b32 s66, s64, 10
    s_add_u32 s65, s65, s66
    s_add_u32 s74, s65, s67
    s_add_u32 s64, s64, 1
    s_lshr_b32 s65, s64, 2
    s_add_u32 m0, s76, 2880
    s_nop 0
    buffer_load_dwordx4 v30, s[4:7], s58 offen offset:192 lds
    s_mul_i32 s65, s65, 77824
    s_lshl_b32 s66, s64, 10
    s_add_u32 s65, s65, s66
    s_add_u32 s21, s65, s67
    s_mul_i32 s64, s48, 245760
    s_mul_i32 s65, s52, 5120
    s_add_u32 s64, s64, s65
    s_add_u32 s42, s64, 4063232
    s_lshl_b32 s77, s50, 1
    s_add_u32 s77, s77, s49
    s_add_u32 m0, s76, 3840
    s_nop 0
    buffer_load_dwordx4 v30, s[4:7], s58 offen offset:256 lds
    s_and_b32 s77, s77, 3
    v_and_b32 v9, 31, v1
    v_lshrrev_b32 v10, 5, v1
    v_lshlrev_b32 v142, 4, v10
    v_lshl_add_u32 v142, v9, 5, v142
    v_mul_u32_u24 v143, 336, v10
    v_lshl_add_u32 v143, v9, 4, v143
    v_add_u32 v9, 11, v9
    v_and_b32 v9, 32, v9
    v_lshl_add_u32 v143, v9, 23, v143
    s_lshr_b32 s71, s49, 1
    s_add_u32 s71, s71, s59
    s_cmp_ge_u32 s71, 10
    s_cselect_b32 s70, 10, 0
    s_sub_u32 s71, s71, s70
    s_bitcmp1_b32 s49, 0
    s_cselect_b32 s70, 10, 0
    s_add_u32 s71, s71, s70
    s_mul_i32 s71, s71, 40960
    s_add_u32 s71, s71, s53
    s_mul_i32 s70, s49, 5120
    s_add_u32 s70, s70, 81920
    s_mov_b32 m0, s70
    s_nop 0
    buffer_load_dwordx4 v12, s[8:11], s71 offen lds
    buffer_load_dwordx4 v13, s[8:11], s71 offen offset:1024 lds
    s_cmp_ge_u32 s2, 232
    s_cselect_b32 s64, 232, 0
    s_sub_u32 s20, s2, s64
    s_mul_i32 s20, s20, 5
    s_min_u32 s69, s48, 4
    s_add_u32 s69, s69, s20
    s_mov_b32 s38, 1966080
    s_mov_b32 s39, 0x20000
    s_cmp_ge_u32 s69, 480
    s_cbranch_scc1 L_h1c_4
    s_mov_b32 s36, s28
    s_mov_b32 s37, s29
    s_mul_hi_u32 s64, s69, 0x0ccccccd
    s_mul_i32 s65, s64, 20
    s_sub_u32 s65, s69, s65
    s_cmp_ge_u32 s65, 10
    s_cselect_b32 s66, 320, 0
    s_cselect_b32 s67, 10, 0
    s_sub_u32 s65, s65, s67
    s_lshr_b32 s67, s65, 1
    s_mul_i32 s67, s67, 80
    s_and_b32 s28, s65, 1
    s_lshl_b32 s28, s28, 5
    s_add_u32 s67, s67, s28
    s_mul_i32 s28, s65, 160
    s_sub_u32 s28, s28, 1216
    s_cmp_lt_u32 s65, 8
    s_cselect_b32 s67, s67, s28
    s_cselect_b32 s31, 16, 80
    s_add_u32 s66, s66, s67
    s_movk_i32 s28, 3072
    s_mov_b32 s29, 4
    s_mov_b32 s30, 8
    s_branch L_h1d_6
L_h1c_4:
    s_sub_u32 s69, s69, 480
    s_mul_hi_u32 s65, s69, 0x1999999a
    s_mul_i32 s64, s65, 10
    s_sub_u32 s64, s69, s64
    s_movk_i32 s28, 1280
    s_cmp_ge_u32 s65, 48
    s_cbranch_scc1 L_h1o_5
    s_mov_b32 s36, s30
    s_mov_b32 s37, s31
    s_mul_hi_u32 s66, s65, 0x2aaaaaab
    s_mul_i32 s67, s66, 6
    s_sub_u32 s65, s65, s67
    s_mul_i32 s66, s66, 192
    s_mul_i32 s67, s65, 48
    s_mul_i32 s29, s65, 96
    s_sub_u32 s29, s29, 352
    s_cmp_lt_u32 s65, 4
    s_cselect_b32 s67, s67, s29
    s_cselect_b32 s31, 16, 48
    s_add_u32 s66, s66, s67
    s_mov_b32 s29, 4
    s_mov_b32 s30, 8
    s_branch L_h1d_6
L_h1o_5:
    s_mov_b32 s36, s40
    s_mov_b32 s37, s41
    s_mov_b32 s38, 819200
    s_sub_u32 s65, s65, 48
    s_cmp_ge_u32 s65, 10
    s_cselect_b32 s66, 320, 0
    s_cselect_b32 s67, 10, 0
    s_sub_u32 s65, s65, s67
    s_mul_i32 s67, s65, 40
    s_mul_i32 s29, s65, 160
    s_sub_u32 s29, s29, 1264
    s_cmp_lt_u32 s65, 8
    s_cselect_b32 s67, s67, s29
    s_cselect_b32 s29, 4, 20
    s_cselect_b32 s30, 20, 40
    s_cselect_b32 s31, 8, 80
    s_add_u32 s66, s66, s67
L_h1d_6:
    s_mul_i32 s82, s66, s28
    s_lshl_b32 s67, s64, 7
    s_add_u32 s82, s82, s67
    v_lshrrev_b32 v18, 5, v1
    v_mul_u32_u24 v18, s29, v18
    v_bfe_u32 v19, v1, 3, 2
    v_add_u32 v18, v18, v19
    v_mul_u32_u24 v18, s28, v18
    v_and_b32 v19, 7, v1
    v_lshl_add_u32 v18, v19, 4, v18
    s_mul_i32 s30, s30, s28
    s_sub_u32 s30, s30, 1024
    s_mul_i32 s31, s31, s28
    s_sub_u32 s31, s31, 2048
    v_add_u32 v19, s30, v18
    v_add_u32 v20, s31, v18
    v_add_u32 v21, s30, v20
    buffer_load_dwordx4 v14, s[8:11], s71 offen offset:2048 lds
    buffer_load_dwordx4 v15, s[8:11], s71 offen offset:3072 lds
    s_lshl_b32 s64, s59, 10
    s_sub_u32 s65, s79, s64
    s_add_u32 s64, s79, s64
    s_add_u32 s65, s65, 5120
    v_add_u32 v247, s65, v8
    v_add_u32 v8, s64, v8
    s_add_u32 m0, s70, 4096
    s_nop 0
    buffer_load_dwordx4 v16, s[8:11], s71 offen lds
    s_add_u32 s64, s49, 8
    s_lshr_b32 s76, s64, 1
    s_add_u32 s76, s76, s59
    s_cmp_ge_u32 s76, 10
    s_cselect_b32 s58, 10, 0
    s_sub_u32 s76, s76, s58
    s_bitcmp1_b32 s64, 0
    s_cselect_b32 s58, 10, 0
    s_add_u32 s76, s76, s58
    s_mul_i32 s76, s76, 40960
    s_add_u32 s76, s76, s53
    s_mul_i32 s58, s64, 5120
    s_add_u32 s58, s58, 81920
    s_add_u32 s70, s70, 20480
    s_add_u32 s71, s71, 81920
    s_mov_b32 m0, s70
    s_nop 0
    buffer_load_dwordx4 v12, s[8:11], s71 offen lds
    buffer_load_dwordx4 v13, s[8:11], s71 offen offset:1024 lds
    buffer_load_dwordx4 v14, s[8:11], s71 offen offset:2048 lds
    s_waitcnt vmcnt(8)
    s_barrier
    ds_read_b128 v[192:195], v8 offset:0
    buffer_load_dwordx4 v15, s[8:11], s71 offen offset:3072 lds
    ds_read_b128 v[196:199], v8 offset:1024
    ds_read_b128 v[200:203], v8 offset:2048
    ds_read_b128 v[204:207], v8 offset:3072
    ds_read_b128 v[208:211], v8 offset:4096
    ds_read_b128 v[212:215], v247 offset:0
    s_add_u32 m0, s70, 4096
    s_nop 0
    buffer_load_dwordx4 v16, s[8:11], s71 offen lds
    ds_read_b128 v[216:219], v247 offset:1024
    ds_read_b128 v[220:223], v247 offset:2048
    ds_read_b128 v[224:227], v247 offset:3072
    ds_read_b128 v[228:231], v247 offset:4096
    ds_read_b64 v[236:237], v244
    s_mov_b32 m0, s58
    s_nop 0
    buffer_load_dwordx4 v12, s[8:11], s76 offen lds
    ds_read_b64 v[238:239], v245
    ds_read_b64 v[254:255], v246
    s_waitcnt lgkmcnt(11)
    v_mfma_f32_16x16x32_bf16 v[112:115], v[248:251], v[192:195], 0
    v_mfma_f32_16x16x32_bf16 v[116:119], v[192:195], v[192:195], 0
    v_mfma_f32_16x16x32_bf16 v[112:115], v[248:251], v[196:199], v[112:115]
    buffer_load_dwordx4 v13, s[8:11], s76 offen offset:1024 lds
    v_mfma_f32_16x16x32_bf16 v[116:119], v[196:199], v[196:199], v[116:119]
    s_waitcnt lgkmcnt(9)
    v_mfma_f32_16x16x32_bf16 v[112:115], v[248:251], v[200:203], v[112:115]
    v_mfma_f32_16x16x32_bf16 v[116:119], v[200:203], v[200:203], v[116:119]
    v_mfma_f32_16x16x32_bf16 v[112:115], v[248:251], v[204:207], v[112:115]
    buffer_load_dwordx4 v14, s[8:11], s76 offen offset:2048 lds
    v_mfma_f32_16x16x32_bf16 v[116:119], v[204:207], v[204:207], v[116:119]
    s_waitcnt lgkmcnt(7)
    v_mfma_f32_16x16x32_bf16 v[112:115], v[248:251], v[208:211], v[112:115]
    v_mfma_f32_16x16x32_bf16 v[116:119], v[208:211], v[208:211], v[116:119]
    v_mfma_f32_16x16x32_bf16 v[112:115], v[248:251], v[212:215], v[112:115]
    v_mfma_f32_16x16x32_bf16 v[116:119], v[212:215], v[212:215], v[116:119]
    buffer_load_dwordx4 v15, s[8:11], s76 offen offset:3072 lds
    s_waitcnt lgkmcnt(5)
    v_mfma_f32_16x16x32_bf16 v[112:115], v[248:251], v[216:219], v[112:115]
    v_mfma_f32_16x16x32_bf16 v[116:119], v[216:219], v[216:219], v[116:119]
    v_mfma_f32_16x16x32_bf16 v[112:115], v[248:251], v[220:223], v[112:115]
    v_mfma_f32_16x16x32_bf16 v[116:119], v[220:223], v[220:223], v[116:119]
    s_add_u32 m0, s58, 4096
    s_nop 0
    buffer_load_dwordx4 v16, s[8:11], s76 offen lds
    s_waitcnt lgkmcnt(3)
    v_mfma_f32_16x16x32_bf16 v[112:115], v[248:251], v[224:227], v[112:115]
    v_mfma_f32_16x16x32_bf16 v[116:119], v[224:227], v[224:227], v[116:119]
    v_mfma_f32_16x16x32_bf16 v[112:115], v[248:251], v[228:231], v[112:115]
    v_mfma_f32_16x16x32_bf16 v[116:119], v[228:231], v[228:231], v[116:119]
    s_waitcnt vmcnt(10)
L_bx:
    v_lshlrev_b32 v11, 2, v1
    v_add_u32 v10, 158976, v11
    v_mov_b32 v7, 158848
    s_add_u32 s64, s48, 12
    s_lshr_b32 s71, s64, 1
    s_add_u32 s71, s71, s59
    s_cmp_ge_u32 s71, 10
    s_cselect_b32 s70, 10, 0
    s_sub_u32 s71, s71, s70
    s_bitcmp1_b32 s64, 0
    s_cselect_b32 s70, 10, 0
    s_add_u32 s71, s71, s70
    s_mul_i32 s71, s71, 40960
    s_add_u32 s71, s71, s53
    s_mul_i32 s70, s64, 5120
    s_add_u32 s70, s70, -61440
    s_lshl_b32 s64, s48, 10
    s_add_u32 s64, s64, 149504
    v_add_u32 v252, s64, v2
    v_add_u32 v11, s64, v11
    s_lshl_b32 s64, s48, 2
    s_add_u32 s64, s64, 40960
    v_lshl_add_u32 v253, v6, 5, s64
    s_waitcnt lgkmcnt(0)
    s_barrier
    ds_read_b32 v7, v7 offset:8
    ds_read2st64_b32 v[12:13], v10 offset0:0 offset1:1
    ds_read2st64_b32 v[14:15], v10 offset0:2 offset1:3
    ds_read2st64_b32 v[16:17], v10 offset0:4 offset1:5
    ds_read_b64_tr_b16 v[32:33], v3 offset:0
    ds_read_b64_tr_b16 v[34:35], v4 offset:0
    ds_read_b64_tr_b16 v[36:37], v3 offset:32
    ds_read_b64_tr_b16 v[38:39], v4 offset:32
    ds_read_b64_tr_b16 v[40:41], v3 offset:64
    ds_read_b64_tr_b16 v[42:43], v4 offset:64
    ds_read_b64_tr_b16 v[44:45], v3 offset:96
    ds_read_b64_tr_b16 v[46:47], v4 offset:96
    ds_read_b64_tr_b16 v[48:49], v3 offset:128
    ds_read_b64_tr_b16 v[50:51], v4 offset:128
    s_waitcnt lgkmcnt(10)
    v_readfirstlane_b32 s54, v7
L_hr_r:
    ds_read_b64_tr_b16 v[52:53], v3 offset:10240
    ds_read_b64_tr_b16 v[54:55], v4 offset:10240
    ds_read_b64_tr_b16 v[56:57], v3 offset:10272
    ds_read_b64_tr_b16 v[58:59], v4 offset:10272
    ds_write_b128 v252, v[116:119]
    ds_write_b32 v11, v112 offset:64
    s_waitcnt lgkmcnt(12)
    v_mfma_f32_16x16x32_bf16 v[120:123], v[32:35], v[192:195], 0
    s_mov_b32 m0, s70
    s_nop 0
    buffer_load_dwordx4 v12, s[8:11], s71 offen lds
    ds_read_b64_tr_b16 v[60:61], v3 offset:10304
    ds_read_b64_tr_b16 v[62:63], v4 offset:10304
    v_mfma_f32_16x16x32_bf16 v[124:127], v[36:39], v[192:195], 0
    v_lshrrev_b32 v9, 2, v6
    v_lshl_add_u32 v9, v9, 4, v6
    ds_read_b64_tr_b16 v[64:65], v3 offset:10336
    ds_read_b64_tr_b16 v[66:67], v4 offset:10336
    s_waitcnt lgkmcnt(12)
    v_mfma_f32_16x16x32_bf16 v[128:131], v[40:43], v[192:195], 0
    v_lshlrev_b32 v9, 2, v9
    ds_read_b64_tr_b16 v[68:69], v3 offset:10368
    ds_read_b64_tr_b16 v[70:71], v4 offset:10368
    v_mfma_f32_16x16x32_bf16 v[132:135], v[44:47], v[192:195], 0
    buffer_load_dwordx4 v13, s[8:11], s71 offen offset:1024 lds
    v_and_b32 v8, 3, v6
    s_waitcnt vmcnt(7)
    s_barrier
    ds_read_b64_tr_b16 v[72:73], v3 offset:20480
    ds_read_b64_tr_b16 v[74:75], v4 offset:20480
    s_setprio 1
    s_waitcnt lgkmcnt(12)
    v_mfma_f32_16x16x32_bf16 v[136:139], v[48:51], v[192:195], 0
    s_cmp_lg_u32 s77, 0
    s_cbranch_scc1 L_cs_17
    v_mfma_f32_16x16x32_bf16 v[160:163], v[248:251], v[32:35], 0
    v_mfma_f32_16x16x32_bf16 v[164:167], v[248:251], v[36:39], 0
    v_mfma_f32_16x16x32_bf16 v[168:171], v[248:251], v[40:43], 0
    v_mfma_f32_16x16x32_bf16 v[172:175], v[248:251], v[44:47], 0
    v_mfma_f32_16x16x32_bf16 v[232:235], v[248:251], v[48:51], 0
L_cs_17:
    v_add_u32 v9, v9, v8
    ds_read_b64_tr_b16 v[76:77], v3 offset:20512
    ds_read_b64_tr_b16 v[78:79], v4 offset:20512
    v_mfma_f32_16x16x32_bf16 v[120:123], v[52:55], v[196:199], v[120:123]
    s_lshl_b32 s64, s49, 10
    s_add_u32 s64, s64, 149504
    ds_read_b64_tr_b16 v[80:81], v3 offset:20544
    ds_read_b64_tr_b16 v[82:83], v4 offset:20544
    s_waitcnt lgkmcnt(10)
    v_mfma_f32_16x16x32_bf16 v[124:127], v[56:59], v[196:199], v[124:127]
    buffer_load_dwordx4 v14, s[8:11], s71 offen offset:2048 lds
    v_lshl_add_u32 v9, v9, 2, s64
    ds_read_b64_tr_b16 v[84:85], v3 offset:20576
    ds_read_b64_tr_b16 v[86:87], v4 offset:20576
    v_mfma_f32_16x16x32_bf16 v[128:131], v[60:63], v[196:199], v[128:131]
    s_add_u32 s64, s64, 64
    ds_read_b64_tr_b16 v[88:89], v3 offset:20608
    ds_read_b64_tr_b16 v[90:91], v4 offset:20608
    s_waitcnt lgkmcnt(10)
    v_mfma_f32_16x16x32_bf16 v[132:135], v[64:67], v[196:199], v[132:135]
    v_lshl_add_u32 v8, v6, 2, s64
    ds_read_b64_tr_b16 v[92:93], v3 offset:30720
    ds_read_b64_tr_b16 v[94:95], v4 offset:30720
    v_mfma_f32_16x16x32_bf16 v[136:139], v[68:71], v[196:199], v[136:139]
    s_cmp_lg_u32 s77, 1
    s_cbranch_scc1 L_cs_18
    v_mfma_f32_16x16x32_bf16 v[160:163], v[248:251], v[52:55], 0
    v_mfma_f32_16x16x32_bf16 v[164:167], v[248:251], v[56:59], 0
    v_mfma_f32_16x16x32_bf16 v[168:171], v[248:251], v[60:63], 0
    v_mfma_f32_16x16x32_bf16 v[172:175], v[248:251], v[64:67], 0
    v_mfma_f32_16x16x32_bf16 v[232:235], v[248:251], v[68:71], 0
L_cs_18:
    buffer_load_dwordx4 v15, s[8:11], s71 offen offset:3072 lds
    ds_read_b64_tr_b16 v[96:97], v3 offset:30752
    ds_read_b64_tr_b16 v[98:99], v4 offset:30752
    s_setprio 0
    s_waitcnt lgkmcnt(10)
    v_mfma_f32_16x16x32_bf16 v[120:123], v[72:75], v[200:203], v[120:123]
    ds_read_b64_tr_b16 v[100:101], v3 offset:30784
    ds_read_b64_tr_b16 v[102:103], v4 offset:30784
    v_mfma_f32_16x16x32_bf16 v[124:127], v[76:79], v[200:203], v[124:127]
    ds_read_b64_tr_b16 v[104:105], v3 offset:30816
    ds_read_b64_tr_b16 v[106:107], v4 offset:30816
    s_waitcnt lgkmcnt(10)
    v_mfma_f32_16x16x32_bf16 v[128:131], v[80:83], v[200:203], v[128:131]
    s_add_u32 m0, s70, 4096
    s_nop 0
    buffer_load_dwordx4 v16, s[8:11], s71 offen lds
    ds_read_b64_tr_b16 v[108:109], v3 offset:30848
    ds_read_b64_tr_b16 v[110:111], v4 offset:30848
    v_mfma_f32_16x16x32_bf16 v[132:135], v[84:87], v[200:203], v[132:135]
    s_waitcnt vmcnt(5)
    s_barrier
    ds_read2st64_b32 v[112:113], v8 offset0:0 offset1:16
    ds_read2st64_b32 v[114:115], v9 offset0:0 offset1:16
    ds_read_b64_tr_b16 v[32:33], v3 offset:40960
    ds_read_b64_tr_b16 v[34:35], v4 offset:40960
    s_setprio 1
    s_waitcnt lgkmcnt(12)
    v_mfma_f32_16x16x32_bf16 v[136:139], v[88:91], v[200:203], v[136:139]
    s_cmp_lg_u32 s77, 2
    s_cbranch_scc1 L_cs_19
    v_mfma_f32_16x16x32_bf16 v[160:163], v[248:251], v[72:75], 0
    v_mfma_f32_16x16x32_bf16 v[164:167], v[248:251], v[76:79], 0
    v_mfma_f32_16x16x32_bf16 v[168:171], v[248:251], v[80:83], 0
    v_mfma_f32_16x16x32_bf16 v[172:175], v[248:251], v[84:87], 0
    v_mfma_f32_16x16x32_bf16 v[232:235], v[248:251], v[88:91], 0
L_cs_19:
    s_min_u32 s65, s48, 4
    s_lshl_b32 s65, s65, 12
    s_add_u32 m0, s65, 81920
    s_nop 0
    buffer_load_dwordx4 v18, s[36:39], s82 offen offset:0 lds
    ds_read_b64_tr_b16 v[36:37], v3 offset:40992
    ds_read_b64_tr_b16 v[38:39], v4 offset:40992
    v_mfma_f32_16x16x32_bf16 v[120:123], v[92:95], v[204:207], v[120:123]
    ds_read_b64_tr_b16 v[40:41], v3 offset:41024
    ds_read_b64_tr_b16 v[42:43], v4 offset:41024
    s_waitcnt lgkmcnt(12)
    v_mfma_f32_16x16x32_bf16 v[124:127], v[96:99], v[204:207], v[124:127]
    buffer_load_dwordx4 v19, s[36:39], s82 offen offset:1024 lds
    ds_read_b64_tr_b16 v[44:45], v3 offset:41056
    ds_read_b64_tr_b16 v[46:47], v4 offset:41056
    v_mfma_f32_16x16x32_bf16 v[128:131], v[100:103], v[204:207], v[128:131]
    ds_read_b64_tr_b16 v[48:49], v3 offset:41088
    ds_read_b64_tr_b16 v[50:51], v4 offset:41088
    s_waitcnt lgkmcnt(12)
    v_mfma_f32_16x16x32_bf16 v[132:135], v[104:107], v[204:207], v[132:135]
    buffer_load_dwordx4 v20, s[36:39], s82 offen offset:2048 lds
    ds_read_b64_tr_b16 v[52:53], v3 offset:51200
    ds_read_b64_tr_b16 v[54:55], v4 offset:51200
    v_mfma_f32_16x16x32_bf16 v[136:139], v[108:111], v[204:207], v[136:139]
    s_cmp_lg_u32 s77, 3
    s_cbranch_scc1 L_cs_20
    v_mfma_f32_16x16x32_bf16 v[160:163], v[248:251], v[92:95], 0
    v_mfma_f32_16x16x32_bf16 v[164:167], v[248:251], v[96:99], 0
    v_mfma_f32_16x16x32_bf16 v[168:171], v[248:251], v[100:103], 0
    v_mfma_f32_16x16x32_bf16 v[172:175], v[248:251], v[104:107], 0
    v_mfma_f32_16x16x32_bf16 v[232:235], v[248:251], v[108:111], 0
L_cs_20:
    ds_read_b64_tr_b16 v[56:57], v3 offset:51232
    ds_read_b64_tr_b16 v[58:59], v4 offset:51232
    s_setprio 0
    s_waitcnt lgkmcnt(10)
    v_mfma_f32_16x16x32_bf16 v[120:123], v[32:35], v[208:211], v[120:123]
    buffer_load_dwordx4 v21, s[36:39], s82 offen offset:3072 lds
    ds_read_b64_tr_b16 v[60:61], v3 offset:51264
    ds_read_b64_tr_b16 v[62:63], v4 offset:51264
    v_mfma_f32_16x16x32_bf16 v[124:127], v[36:39], v[208:211], v[124:127]
    ds_read_b64_tr_b16 v[64:65], v3 offset:51296
    ds_read_b64_tr_b16 v[66:67], v4 offset:51296
    s_waitcnt lgkmcnt(10)
    v_mfma_f32_16x16x32_bf16 v[128:131], v[40:43], v[208:211], v[128:131]
    s_waitcnt lgkmcnt(14)
    v_add_f32 v140, v112, v113
    v_add_f32 v141, v114, v115
    ds_read_b64_tr_b16 v[68:69], v3 offset:51328
    ds_read_b64_tr_b16 v[70:71], v4 offset:51328
    v_mfma_f32_16x16x32_bf16 v[132:135], v[44:47], v[208:211], v[132:135]
    v_mul_f32 v140, s27, v140
    v_mul_f32 v141, s27, v141
    v_fma_f32 v141, -v140, v140, v141
    s_cmp_ge_u32 s48, 4
    s_cbranch_scc1 L_c2s
    s_waitcnt vmcnt(4)
L_c2s:
    s_barrier
    v_subrev_u32 v3, 81920, v3
    v_subrev_u32 v4, 81920, v4
    ds_read_b64_tr_b16 v[72:73], v3 offset:0
    ds_read_b64_tr_b16 v[74:75], v4 offset:0
    s_setprio 1
    s_waitcnt lgkmcnt(10)
    v_mfma_f32_16x16x32_bf16 v[136:139], v[48:51], v[208:211], v[136:139]
    s_cmp_lg_u32 s77, 0
    s_cbranch_scc1 L_cs_21
    v_mfma_f32_16x16x32_bf16 v[160:163], v[248:251], v[32:35], v[160:163]
    v_mfma_f32_16x16x32_bf16 v[164:167], v[248:251], v[36:39], v[164:167]
    v_mfma_f32_16x16x32_bf16 v[168:171], v[248:251], v[40:43], v[168:171]
    v_mfma_f32_16x16x32_bf16 v[172:175], v[248:251], v[44:47], v[172:175]
    v_mfma_f32_16x16x32_bf16 v[232:235], v[248:251], v[48:51], v[232:235]
L_cs_21:
    s_movk_i32 s64, 4096
    buffer_load_dword v29, v28, s[12:15], s64 offen sc1
    v_max_f32 v141, 0, v141
    v_add_f32 v141, s32, v141
    v_rsq_f32 v141, v141
    ds_read_b64_tr_b16 v[76:77], v3 offset:32
    ds_read_b64_tr_b16 v[78:79], v4 offset:32
    v_mfma_f32_16x16x32_bf16 v[120:123], v[52:55], v[212:215], v[120:123]
    v_and_b32 v6, 31, v1
    v_mul_f32 v141, 1051011932, v141
    v_mul_f32 v140, v140, v141
    ds_read_b64_tr_b16 v[80:81], v3 offset:64
    ds_read_b64_tr_b16 v[82:83], v4 offset:64
    s_waitcnt lgkmcnt(10)
    v_mfma_f32_16x16x32_bf16 v[124:127], v[56:59], v[212:215], v[124:127]
    v_lshlrev_b32 v6, 3, v6
    v_add_u32 v6, 102400, v6
    v_lshrrev_b32 v7, 5, v1
    ds_read_b64_tr_b16 v[84:85], v3 offset:96
    ds_read_b64_tr_b16 v[86:87], v4 offset:96
    v_mfma_f32_16x16x32_bf16 v[128:131], v[60:63], v[212:215], v[128:131]
    v_lshl_add_u32 v9, v7, 9, v6
    v_mul_u32_u24 v10, 9216, v7
    v_add_u32 v10, v10, v6
    ds_read_b64_tr_b16 v[88:89], v3 offset:128
    ds_read_b64_tr_b16 v[90:91], v4 offset:128
    s_waitcnt lgkmcnt(10)
    v_mfma_f32_16x16x32_bf16 v[132:135], v[64:67], v[212:215], v[132:135]
    v_lshlrev_b32 v7, 10, v7
    v_sub_u32 v11, 1280, v7
    s_add_u32 s64, s75, 61440
    ds_read_b64_tr_b16 v[92:93], v3 offset:10240
    ds_read_b64_tr_b16 v[94:95], v4 offset:10240
    v_mfma_f32_16x16x32_bf16 v[136:139], v[68:71], v[212:215], v[136:139]
    s_cmp_lg_u32 s77, 1
    s_cbranch_scc1 L_cs_22
    v_mfma_f32_16x16x32_bf16 v[160:163], v[248:251], v[52:55], v[160:163]
    v_mfma_f32_16x16x32_bf16 v[164:167], v[248:251], v[56:59], v[164:167]
    v_mfma_f32_16x16x32_bf16 v[168:171], v[248:251], v[60:63], v[168:171]
    v_mfma_f32_16x16x32_bf16 v[172:175], v[248:251], v[64:67], v[172:175]
    v_mfma_f32_16x16x32_bf16 v[232:235], v[248:251], v[68:71], v[232:235]
L_cs_22:
    v_add_u32 v8, s64, v2
    v_lshrrev_b32 v31, 4, v1
    v_lshlrev_b32 v31, 4, v31
    ds_read_b64_tr_b16 v[96:97], v3 offset:10272
    ds_read_b64_tr_b16 v[98:99], v4 offset:10272
    s_setprio 0
    s_waitcnt lgkmcnt(10)
    v_mfma_f32_16x16x32_bf16 v[120:123], v[72:75], v[216:219], v[120:123]
    v_add_u32 v31, 45056, v31
    s_mul_i32 s64, s50, 48
    v_add_u32 v30, s64, v1
    ds_read_b64_tr_b16 v[100:101], v3 offset:10304
    ds_read_b64_tr_b16 v[102:103], v4 offset:10304
    v_mfma_f32_16x16x32_bf16 v[124:127], v[76:79], v[216:219], v[124:127]
    v_lshlrev_b32 v0, 2, v30
    v_lshlrev_b32 v30, 5, v30
    ds_read_b64_tr_b16 v[104:105], v3 offset:10336
    ds_read_b64_tr_b16 v[106:107], v4 offset:10336
    s_waitcnt lgkmcnt(10)
    v_mfma_f32_16x16x32_bf16 v[128:131], v[80:83], v[216:219], v[128:131]
    ds_read_b64_tr_b16 v[108:109], v3 offset:10368
    ds_read_b64_tr_b16 v[110:111], v4 offset:10368
    v_mfma_f32_16x16x32_bf16 v[132:135], v[84:87], v[216:219], v[132:135]
    s_waitcnt vmcnt(5)
    s_barrier
    ds_read_b64_tr_b16 v[32:33], v3 offset:20480
    ds_read_b64_tr_b16 v[34:35], v4 offset:20480
    ds_read_b64_tr_b16 v[36:37], v3 offset:20512
    ds_read_b64_tr_b16 v[38:39], v4 offset:20512
    s_setprio 3
    s_waitcnt lgkmcnt(12)
    v_mfma_f32_16x16x32_bf16 v[136:139], v[88:91], v[216:219], v[136:139]
    s_cmp_lg_u32 s77, 2
    s_cbranch_scc1 L_cs_23
    v_mfma_f32_16x16x32_bf16 v[160:163], v[248:251], v[72:75], v[160:163]
    v_mfma_f32_16x16x32_bf16 v[164:167], v[248:251], v[76:79], v[164:167]
    v_mfma_f32_16x16x32_bf16 v[168:171], v[248:251], v[80:83], v[168:171]
    v_mfma_f32_16x16x32_bf16 v[172:175], v[248:251], v[84:87], v[172:175]
    v_mfma_f32_16x16x32_bf16 v[232:235], v[248:251], v[88:91], v[232:235]
L_cs_23:
    ds_read_b64_tr_b16 v[40:41], v3 offset:20544
    ds_read_b64_tr_b16 v[42:43], v4 offset:20544
    ds_read_b64_tr_b16 v[44:45], v3 offset:20576
    ds_read_b64_tr_b16 v[46:47], v4 offset:20576
    v_mfma_f32_16x16x32_bf16 v[120:123], v[92:95], v[220:223], v[120:123]
    ds_read_b64_tr_b16 v[48:49], v3 offset:20608
    ds_read_b64_tr_b16 v[50:51], v4 offset:20608
    ds_read_b64_tr_b16 v[52:53], v3 offset:30720
    ds_read_b64_tr_b16 v[54:55], v4 offset:30720
    s_waitcnt lgkmcnt(14)
    v_mfma_f32_16x16x32_bf16 v[124:127], v[96:99], v[220:223], v[124:127]
    s_waitcnt vmcnt(0)
    v_cmp_ne_u32 vcc, s54, v29
    ds_read_b64_tr_b16 v[56:57], v3 offset:30752
    ds_read_b64_tr_b16 v[58:59], v4 offset:30752
    ds_read_b64_tr_b16 v[60:61], v3 offset:30784
    ds_read_b64_tr_b16 v[62:63], v4 offset:30784
    v_mfma_f32_16x16x32_bf16 v[128:131], v[100:103], v[220:223], v[128:131]
    s_cbranch_vccnz L_ke_7
    buffer_load_dwordx4 v[240:243], v2, s[12:15], s34 offen offset:0 sc1
L_ke_7:
    ds_read_b64_tr_b16 v[64:65], v3 offset:30816
    ds_read_b64_tr_b16 v[66:67], v4 offset:30816
    ds_read_b64_tr_b16 v[68:69], v3 offset:30848
    ds_read_b64_tr_b16 v[70:71], v4 offset:30848
    s_waitcnt lgkmcnt(14)
    v_mfma_f32_16x16x32_bf16 v[132:135], v[104:107], v[220:223], v[132:135]
    s_cbranch_vccnz L_ke_8
    buffer_load_dwordx4 v[144:147], v142, s[12:15], s3 offen offset:0 sc1
L_ke_8:
    v_mfma_f32_16x16x32_bf16 v[136:139], v[108:111], v[220:223], v[136:139]
    s_cmp_lg_u32 s77, 3
    s_cbranch_scc1 L_cs_24
    v_mfma_f32_16x16x32_bf16 v[160:163], v[248:251], v[92:95], v[160:163]
    v_mfma_f32_16x16x32_bf16 v[164:167], v[248:251], v[96:99], v[164:167]
    v_mfma_f32_16x16x32_bf16 v[168:171], v[248:251], v[100:103], v[168:171]
    v_mfma_f32_16x16x32_bf16 v[172:175], v[248:251], v[104:107], v[172:175]
    v_mfma_f32_16x16x32_bf16 v[232:235], v[248:251], v[108:111], v[232:235]
L_cs_24:
    s_setprio 2
    s_waitcnt lgkmcnt(14)
    v_mfma_f32_16x16x32_bf16 v[120:123], v[32:35], v[224:227], v[120:123]
    s_cbranch_vccnz L_ke_9
    buffer_load_dwordx4 v[176:179], v143, s[12:15], s35 offen offset:0 sc1
L_ke_9:
    s_waitcnt lgkmcnt(0)
    s_cmp_lg_u32 s77, 0
    s_cbranch_scc1 L_cs_15
    v_mfma_f32_16x16x32_bf16 v[160:163], v[248:251], v[32:35], v[160:163]
    v_mfma_f32_16x16x32_bf16 v[164:167], v[248:251], v[36:39], v[164:167]
    v_mfma_f32_16x16x32_bf16 v[168:171], v[248:251], v[40:43], v[168:171]
    v_mfma_f32_16x16x32_bf16 v[172:175], v[248:251], v[44:47], v[172:175]
    v_mfma_f32_16x16x32_bf16 v[232:235], v[248:251], v[48:51], v[232:235]
L_cs_15:
    s_cmp_lg_u32 s77, 1
    s_cbranch_scc1 L_cs_16
    v_mfma_f32_16x16x32_bf16 v[160:163], v[248:251], v[52:55], v[160:163]
    v_mfma_f32_16x16x32_bf16 v[164:167], v[248:251], v[56:59], v[164:167]
    v_mfma_f32_16x16x32_bf16 v[168:171], v[248:251], v[60:63], v[168:171]
    v_mfma_f32_16x16x32_bf16 v[172:175], v[248:251], v[64:67], v[172:175]
    v_mfma_f32_16x16x32_bf16 v[232:235], v[248:251], v[68:71], v[232:235]
L_cs_16:
    v_mfma_f32_16x16x32_bf16 v[124:127], v[36:39], v[224:227], v[124:127]
    s_cbranch_vccnz L_ke_10
    buffer_load_dwordx4 v[180:183], v143, s[12:15], s35 offen offset:672 sc1
L_ke_10:
    s_waitcnt lgkmcnt(12)
    v_mfma_f32_16x16x32_bf16 v[128:131], v[40:43], v[224:227], v[128:131]
    ds_write2st64_b32 v253, v160, v164 offset0:0 offset1:2
    s_nop 0
    ds_write2st64_b32 v253, v168, v172 offset0:4 offset1:6
    ds_write_b32 v253, v232 offset:2048
    v_mfma_f32_16x16x32_bf16 v[132:135], v[44:47], v[224:227], v[132:135]
    s_cbranch_vccnz L_ke_11
    buffer_load_dwordx4 v[148:151], v142, s[12:15], s3 offen offset:1024 sc1
L_ke_11:
    s_setprio 1
    s_waitcnt lgkmcnt(11)
    v_mfma_f32_16x16x32_bf16 v[136:139], v[48:51], v[224:227], v[136:139]
    v_mfma_f32_16x16x32_bf16 v[120:123], v[52:55], v[228:231], v[120:123]
    s_cbranch_vccnz L_ke_12
    buffer_load_dwordx4 v[184:187], v143, s[12:15], s35 offen offset:1344 sc1
L_ke_12:
    s_waitcnt lgkmcnt(0)
    s_barrier
    ds_read_b128 v[160:163], v30 offset:40960
    ds_read_b128 v[164:167], v30 offset:40976
    s_waitcnt lgkmcnt(9)
    v_mfma_f32_16x16x32_bf16 v[124:127], v[56:59], v[228:231], v[124:127]
    s_cbranch_vccnz L_ke_13
    buffer_load_dwordx4 v[188:191], v143, s[12:15], s35 offen offset:2016 sc1
L_ke_13:
    s_setprio 0
    v_mfma_f32_16x16x32_bf16 v[128:131], v[60:63], v[228:231], v[128:131]
    s_waitcnt lgkmcnt(5)
    v_mfma_f32_16x16x32_bf16 v[132:135], v[64:67], v[228:231], v[132:135]
    s_cbranch_vccnz L_ke_14
    buffer_load_dwordx4 v[244:247], v2, s[12:15], s34 offen offset:1024 sc1
L_ke_14:
    v_mfma_f32_16x16x32_bf16 v[136:139], v[68:71], v[228:231], v[136:139]
    s_waitcnt lgkmcnt(0)
    v_add_f32 v160, v160, v164
    v_add_f32 v161, v161, v165
    v_add_f32 v162, v162, v166
    v_add_f32 v163, v163, v167
    v_add_f32 v160, v160, v161
    v_add_f32 v162, v162, v163
    v_add_f32 v160, v160, v162
    ds_write_b32 v0, v160 offset:45056
    s_cmp_lg_u32 s50, 0
    s_cbranch_scc1 L_q1
    ds_write_b128 v8, v[132:135] offset:3072
    ds_write_b128 v8, v[136:139] offset:4096
    s_cbranch_vccnz L_ke_25
    buffer_load_dwordx4 v[152:155], v142, s[12:15], s3 offen offset:2048 sc1
L_ke_25:
    s_cbranch_vccnz L_ke_26
    buffer_load_dwordx4 v[192:195], v143, s[12:15], s35 offen offset:2688 sc1
L_ke_26:
    v_pk_mul_f32 v[120:121], v[120:121], v[140:141] op_sel:[0,1] op_sel_hi:[1,1]
    v_pk_mul_f32 v[122:123], v[122:123], v[140:141] op_sel:[0,1] op_sel_hi:[1,1]
    v_pk_mul_f32 v[124:125], v[124:125], v[140:141] op_sel:[0,1] op_sel_hi:[1,1]
    v_pk_mul_f32 v[126:127], v[126:127], v[140:141] op_sel:[0,1] op_sel_hi:[1,1]
    v_pk_mul_f32 v[128:129], v[128:129], v[140:141] op_sel:[0,1] op_sel_hi:[1,1]
    v_pk_mul_f32 v[130:131], v[130:131], v[140:141] op_sel:[0,1] op_sel_hi:[1,1]
    s_waitcnt lgkmcnt(0)
    s_barrier
    ds_read_b128 v[32:35], v31 offset:0
    ds_read_b128 v[44:47], v8 offset:0
    ds_read_b128 v[36:39], v31 offset:64
    ds_read_b128 v[48:51], v8 offset:1024
    ds_read_b128 v[40:43], v31 offset:128
    ds_read_b128 v[52:55], v8 offset:2048
    s_cbranch_vccnz L_ke_27
    buffer_load_dwordx4 v[196:199], v143, s[12:15], s35 offen offset:3360 sc1
L_ke_27:
    s_cbranch_vccnz L_ke_28
    buffer_load_dwordx4 v[156:159], v142, s[12:15], s3 offen offset:3072 sc1
L_ke_28:
    s_lshl_b32 s64, s48, 11
    s_add_u32 s64, s64, 139264
    v_add_u32 v22, s64, v2
    v_add_u32 v3, 0, v2
    s_waitcnt lgkmcnt(4)
    v_pk_fma_f32 v[120:121], v[44:45], v[140:141], v[120:121] op_sel:[0,1,0] op_sel_hi:[1,1,1]
    v_pk_fma_f32 v[122:123], v[46:47], v[140:141], v[122:123] op_sel:[0,1,0] op_sel_hi:[1,1,1]
    v_pk_fma_f32 v[120:121], v[32:33], v[140:141], v[120:121] op_sel:[0,0,0] op_sel_hi:[1,0,1] neg_lo:[1,0,0] neg_hi:[1,0,0]
    v_pk_fma_f32 v[122:123], v[34:35], v[140:141], v[122:123] op_sel:[0,0,0] op_sel_hi:[1,0,1] neg_lo:[1,0,0] neg_hi:[1,0,0]
    v_cvt_pk_bf16_f32 v80, v120, v121
    v_cvt_pk_bf16_f32 v81, v122, v123
    ds_write_b64 v27, v[80:81] offset:0
    s_waitcnt lgkmcnt(3)
    v_pk_fma_f32 v[124:125], v[48:49], v[140:141], v[124:125] op_sel:[0,1,0] op_sel_hi:[1,1,1]
    v_pk_fma_f32 v[126:127], v[50:51], v[140:141], v[126:127] op_sel:[0,1,0] op_sel_hi:[1,1,1]
    v_pk_fma_f32 v[124:125], v[36:37], v[140:141], v[124:125] op_sel:[0,0,0] op_sel_hi:[1,0,1] neg_lo:[1,0,0] neg_hi:[1,0,0]
    v_pk_fma_f32 v[126:127], v[38:39], v[140:141], v[126:127] op_sel:[0,0,0] op_sel_hi:[1,0,1] neg_lo:[1,0,0] neg_hi:[1,0,0]
    v_cvt_pk_bf16_f32 v82, v124, v125
    v_cvt_pk_bf16_f32 v83, v126, v127
    ds_write_b64 v27, v[82:83] offset:1024
    s_waitcnt lgkmcnt(2)
    v_pk_fma_f32 v[128:129], v[52:53], v[140:141], v[128:129] op_sel:[0,1,0] op_sel_hi:[1,1,1]
    v_pk_fma_f32 v[130:131], v[54:55], v[140:141], v[130:131] op_sel:[0,1,0] op_sel_hi:[1,1,1]
    v_pk_fma_f32 v[128:129], v[40:41], v[140:141], v[128:129] op_sel:[0,0,0] op_sel_hi:[1,0,1] neg_lo:[1,0,0] neg_hi:[1,0,0]
    v_pk_fma_f32 v[130:131], v[42:43], v[140:141], v[130:131] op_sel:[0,0,0] op_sel_hi:[1,0,1] neg_lo:[1,0,0] neg_hi:[1,0,0]
    v_cvt_pk_bf16_f32 v84, v128, v129
    v_cvt_pk_bf16_f32 v85, v130, v131
    ds_write_b64 v27, v[84:85] offset:2048
    s_branch L_q_j
L_q1:
    ds_write_b128 v8, v[120:123] offset:0
    ds_write_b128 v8, v[124:127] offset:1024
    ds_write_b128 v8, v[128:131] offset:2048
    s_cbranch_vccnz L_ke_29
    buffer_load_dwordx4 v[152:155], v142, s[12:15], s3 offen offset:2048 sc1
L_ke_29:
    s_cbranch_vccnz L_ke_30
    buffer_load_dwordx4 v[192:195], v143, s[12:15], s35 offen offset:2688 sc1
L_ke_30:
    v_pk_mul_f32 v[132:133], v[132:133], v[140:141] op_sel:[0,1] op_sel_hi:[1,1]
    v_pk_mul_f32 v[134:135], v[134:135], v[140:141] op_sel:[0,1] op_sel_hi:[1,1]
    v_pk_mul_f32 v[136:137], v[136:137], v[140:141] op_sel:[0,1] op_sel_hi:[1,1]
    v_pk_mul_f32 v[138:139], v[138:139], v[140:141] op_sel:[0,1] op_sel_hi:[1,1]
    s_waitcnt lgkmcnt(0)
    s_barrier
    ds_read_b128 v[32:35], v31 offset:192
    ds_read_b128 v[44:47], v8 offset:3072
    ds_read_b128 v[36:39], v31 offset:256
    ds_read_b128 v[48:51], v8 offset:4096
    s_cbranch_vccnz L_ke_31
    buffer_load_dwordx4 v[196:199], v143, s[12:15], s35 offen offset:3360 sc1
L_ke_31:
    s_cbranch_vccnz L_ke_32
    buffer_load_dwordx4 v[156:159], v142, s[12:15], s3 offen offset:3072 sc1
L_ke_32:
    s_lshl_b32 s64, s48, 11
    s_add_u32 s64, s64, 139264
    v_add_u32 v22, s64, v2
    v_add_u32 v3, 51200, v2
    s_waitcnt lgkmcnt(2)
    v_pk_fma_f32 v[132:133], v[44:45], v[140:141], v[132:133] op_sel:[0,1,0] op_sel_hi:[1,1,1]
    v_pk_fma_f32 v[134:135], v[46:47], v[140:141], v[134:135] op_sel:[0,1,0] op_sel_hi:[1,1,1]
    v_pk_fma_f32 v[132:133], v[32:33], v[140:141], v[132:133] op_sel:[0,0,0] op_sel_hi:[1,0,1] neg_lo:[1,0,0] neg_hi:[1,0,0]
    v_pk_fma_f32 v[134:135], v[34:35], v[140:141], v[134:135] op_sel:[0,0,0] op_sel_hi:[1,0,1] neg_lo:[1,0,0] neg_hi:[1,0,0]
    v_cvt_pk_bf16_f32 v80, v132, v133
    v_cvt_pk_bf16_f32 v81, v134, v135
    ds_write_b64 v27, v[80:81] offset:0
    s_waitcnt lgkmcnt(1)
    v_pk_fma_f32 v[136:137], v[48:49], v[140:141], v[136:137] op_sel:[0,1,0] op_sel_hi:[1,1,1]
    v_pk_fma_f32 v[138:139], v[50:51], v[140:141], v[138:139] op_sel:[0,1,0] op_sel_hi:[1,1,1]
    v_pk_fma_f32 v[136:137], v[36:37], v[140:141], v[136:137] op_sel:[0,0,0] op_sel_hi:[1,0,1] neg_lo:[1,0,0] neg_hi:[1,0,0]
    v_pk_fma_f32 v[138:139], v[38:39], v[140:141], v[138:139] op_sel:[0,0,0] op_sel_hi:[1,0,1] neg_lo:[1,0,0] neg_hi:[1,0,0]
    v_cvt_pk_bf16_f32 v82, v136, v137
    v_cvt_pk_bf16_f32 v83, v138, v139
    ds_write_b64 v27, v[82:83] offset:1024
L_q_j:
    ds_write_b128 v22, v[236:239]
    ds_write_b64 v22, v[254:255] offset:1024
    s_cbranch_vccnz L_kv_spin0
    buffer_load_dwordx4 v[200:203], v143, s[12:15], s35 offen offset:4032 sc1
    s_add_u32 s65, s35, 4096
    buffer_load_dwordx4 v[204:207], v143, s[12:15], s65 offen offset:608 sc1
L_kv_done:
    s_add_u32 s64, s48, 1
    s_and_b32 s64, s64, 7
    v_mad_u32_u24 v7, v11, s64, v10
    s_mul_i32 s64, s64, 1280
    v_add_u32 v6, s64, v9
    s_mov_b32 s30, 1400897536
    s_mov_b32 s31, 0
    s_waitcnt lgkmcnt(0)
    s_barrier
    ds_read2_b64 v[12:15], v6 offset0:0 offset1:32
    s_mov_b32 exec_hi, 0
    ds_read_b64 v[16:17], v7 offset:1024
    s_not_b64 exec, exec
    v_mov_b32 v16, 0
    v_mov_b32 v17, 0
    s_mov_b64 exec, -1
    s_waitcnt vmcnt(12) lgkmcnt(0)
    v_mfma_f32_32x32x16_bf16 v[48:63], v[144:147], v[12:15], 0
    v_mfma_f32_32x32x8_bf16 v[48:63], v[240:241], v[16:17], v[48:63]
    v_mfma_f32_32x32x16_bf16 v[32:47], v[144:147], v[12:15], 0
    s_nop 10
    v_max3_f32 v24, v48, v49, v50
    v_max_f32 v24, v24, v51
    v_max3_f32 v24, v24, v52, v53
    v_max3_f32 v24, v24, v54, v55
    v_max3_f32 v24, v24, v56, v57
    v_max3_f32 v24, v24, v58, v59
    v_max3_f32 v24, v24, v60, v61
    v_max3_f32 v24, v24, v62, v63
    v_mov_b32 v25, v24
    s_nop 1
    v_permlane32_swap_b32 v25, v24
    v_max_f32 v24, v24, v25
    v_xor_b32 v24, 0x80000000, v24
    v_and_b32 v25, 0xffff0000, v24
    v_sub_f32 v24, v24, v25
    v_and_b32 v26, 0xffff0000, v24
    v_sub_f32 v24, v24, v26
    s_mov_b32 exec_lo, 0
    v_lshrrev_b32 v25, 16, v25
    v_or_b32 v16, v25, v26
    v_lshrrev_b32 v17, 16, v24
    ds_write_b64 v7, v[16:17] offset:1024
    s_mov_b32 exec_lo, -1
    v_mfma_f32_32x32x8_bf16 v[32:47], v[240:241], v[16:17], v[32:47]
    s_setprio 2
    s_nop 10
    v_exp_f32 v32, v32
    v_exp_f32 v33, v33
    v_exp_f32 v34, v34
    buffer_load_dwordx4 v[248:251], v2, s[12:15], s34 offen offset:2048 sc1
    v_exp_f32 v35, v35
    v_exp_f32 v36, v36
    v_exp_f32 v37, v37
    v_exp_f32 v38, v38
    s_waitcnt vmcnt(10)
    v_mfma_f32_32x32x16_bf16 v[48:63], v[148:151], v[12:15], 0
    s_add_u32 s65, s3, 4096
    buffer_load_dwordx4 v[160:163], v142, s[12:15], s65 offen offset:0 sc1
    v_exp_f32 v39, v39
    v_cvt_pk_bf16_f32 v24, v32, v33
    v_cvt_pk_bf16_f32 v25, v34, v35
    v_cvt_pk_bf16_f32 v26, v36, v37
    v_exp_f32 v40, v40
    v_cvt_pk_bf16_f32 v27, v38, v39
    v_mfma_f32_32x32x8_bf16 v[48:63], v[242:243], v[16:17], v[48:63]
    v_exp_f32 v41, v41
    v_exp_f32 v42, v42
    v_exp_f32 v43, v43
    v_exp_f32 v44, v44
    v_mfma_f32_32x32x16_bf16 v[64:79], v[176:179], v[24:27], 0
    s_add_u32 s65, s35, 4096
    buffer_load_dwordx4 v[208:211], v143, s[12:15], s65 offen offset:1280 sc1
    v_exp_f32 v45, v45
    v_exp_f32 v46, v46
    v_exp_f32 v47, v47
    v_cvt_pk_bf16_f32 v28, v40, v41
    v_cvt_pk_bf16_f32 v29, v42, v43
    v_cvt_pk_bf16_f32 v30, v44, v45
    v_cvt_pk_bf16_f32 v31, v46, v47
    s_setprio 1
    v_exp_f32 v48, v48
    v_exp_f32 v49, v49
    v_exp_f32 v50, v50
    v_mfma_f32_32x32x16_bf16 v[64:79], v[180:183], v[28:31], v[64:79]
    s_add_u32 s65, s35, 4096
    buffer_load_dwordx4 v[212:215], v143, s[12:15], s65 offen offset:1952 sc1
    v_exp_f32 v51, v51
    v_exp_f32 v52, v52
    v_exp_f32 v53, v53
    v_exp_f32 v54, v54
    s_waitcnt vmcnt(9)
    v_mfma_f32_32x32x16_bf16 v[32:47], v[152:155], v[12:15], 0
    s_add_u32 s65, s3, 4096
    buffer_load_dwordx4 v[164:167], v142, s[12:15], s65 offen offset:1024 sc1
    v_exp_f32 v55, v55
    v_cvt_pk_bf16_f32 v24, v48, v49
    v_cvt_pk_bf16_f32 v25, v50, v51
    v_cvt_pk_bf16_f32 v26, v52, v53
    v_exp_f32 v56, v56
    v_cvt_pk_bf16_f32 v27, v54, v55
    v_mfma_f32_32x32x8_bf16 v[32:47], v[244:245], v[16:17], v[32:47]
    v_exp_f32 v57, v57
    v_exp_f32 v58, v58
    v_exp_f32 v59, v59
    v_exp_f32 v60, v60
    v_mfma_f32_32x32x16_bf16 v[64:79], v[184:187], v[24:27], v[64:79]
    s_add_u32 s65, s35, 4096
    buffer_load_dwordx4 v[216:219], v143, s[12:15], s65 offen offset:2624 sc1
    v_exp_f32 v61, v61
    v_exp_f32 v62, v62
    v_exp_f32 v63, v63
    v_cvt_pk_bf16_f32 v28, v56, v57
    v_cvt_pk_bf16_f32 v29, v58, v59
    v_cvt_pk_bf16_f32 v30, v60, v61
    v_cvt_pk_bf16_f32 v31, v62, v63
    s_setprio 0
    v_exp_f32 v32, v32
    v_exp_f32 v33, v33
    v_exp_f32 v34, v34
    v_mfma_f32_32x32x16_bf16 v[64:79], v[188:191], v[28:31], v[64:79]
    s_add_u32 s65, s35, 4096
    buffer_load_dwordx4 v[220:223], v143, s[12:15], s65 offen offset:3296 sc1
    v_exp_f32 v35, v35
    v_exp_f32 v36, v36
    v_exp_f32 v37, v37
    v_exp_f32 v38, v38
    s_waitcnt vmcnt(9)
    v_mfma_f32_32x32x16_bf16 v[48:63], v[156:159], v[12:15], 0
    buffer_load_dwordx4 v[252:255], v2, s[12:15], s34 offen offset:3072 sc1
    v_exp_f32 v39, v39
    v_cvt_pk_bf16_f32 v24, v32, v33
    v_cvt_pk_bf16_f32 v25, v34, v35
    v_cvt_pk_bf16_f32 v26, v36, v37
    v_exp_f32 v40, v40
    v_cvt_pk_bf16_f32 v27, v38, v39
    v_mfma_f32_32x32x8_bf16 v[48:63], v[246:247], v[16:17], v[48:63]
    v_exp_f32 v41, v41
    v_exp_f32 v42, v42
    v_exp_f32 v43, v43
    v_exp_f32 v44, v44
    v_mfma_f32_32x32x16_bf16 v[64:79], v[192:195], v[24:27], v[64:79]
    s_add_u32 s65, s3, 4096
    buffer_load_dwordx4 v[168:171], v142, s[12:15], s65 offen offset:2048 sc1
    v_exp_f32 v45, v45
    v_exp_f32 v46, v46
    v_exp_f32 v47, v47
    v_cvt_pk_bf16_f32 v28, v40, v41
    v_cvt_pk_bf16_f32 v29, v42, v43
    v_cvt_pk_bf16_f32 v30, v44, v45
    v_cvt_pk_bf16_f32 v31, v46, v47
    s_setprio 3
    s_waitcnt lgkmcnt(0)
    s_barrier
    s_add_u32 s64, s48, 1
    s_and_b32 s64, s64, 7
    s_mul_i32 s64, s64, 3072
    s_add_u32 s64, s64, 114688
    v_add_u32 v8, s64, v2
    v_exp_f32 v48, v48
    v_exp_f32 v49, v49
    v_exp_f32 v50, v50
    v_mfma_f32_32x32x16_bf16 v[64:79], v[196:199], v[28:31], v[64:79]
    s_add_u32 s65, s35, 4096
    buffer_load_dwordx4 v[224:227], v143, s[12:15], s65 offen offset:3968 sc1
    v_exp_f32 v51, v51
    v_exp_f32 v52, v52
    v_exp_f32 v53, v53
    v_exp_f32 v54, v54
    s_waitcnt vmcnt(8)
    v_mfma_f32_32x32x16_bf16 v[32:47], v[160:163], v[12:15], 0
    s_add_u32 s65, s35, 8192
    buffer_load_dwordx4 v[228:231], v143, s[12:15], s65 offen offset:544 sc1
    v_exp_f32 v55, v55
    v_cvt_pk_bf16_f32 v24, v48, v49
    v_cvt_pk_bf16_f32 v25, v50, v51
    v_cvt_pk_bf16_f32 v26, v52, v53
    v_exp_f32 v56, v56
    v_cvt_pk_bf16_f32 v27, v54, v55
    v_mfma_f32_32x32x8_bf16 v[32:47], v[248:249], v[16:17], v[32:47]
    v_exp_f32 v57, v57
    v_exp_f32 v58, v58
    v_exp_f32 v59, v59
    v_exp_f32 v60, v60
    v_mfma_f32_32x32x16_bf16 v[64:79], v[200:203], v[24:27], v[64:79]
    s_add_u32 s65, s3, 4096
    buffer_load_dwordx4 v[172:175], v142, s[12:15], s65 offen offset:3072 sc1
    v_exp_f32 v61, v61
    v_exp_f32 v62, v62
    v_exp_f32 v63, v63
    v_cvt_pk_bf16_f32 v28, v56, v57
    v_cvt_pk_bf16_f32 v29, v58, v59
    v_cvt_pk_bf16_f32 v30, v60, v61
    v_cvt_pk_bf16_f32 v31, v62, v63
    v_exp_f32 v32, v32
    v_exp_f32 v33, v33
    v_exp_f32 v34, v34
    v_mfma_f32_32x32x16_bf16 v[64:79], v[204:207], v[28:31], v[64:79]
    s_add_u32 s65, s35, 8192
    buffer_load_dwordx4 v[232:235], v143, s[12:15], s65 offen offset:1216 sc1
    v_exp_f32 v35, v35
    v_exp_f32 v36, v36
    v_exp_f32 v37, v37
    v_exp_f32 v38, v38
    s_waitcnt vmcnt(8)
    v_mfma_f32_32x32x16_bf16 v[48:63], v[164:167], v[12:15], 0
    s_add_u32 s65, s35, 8192
    buffer_load_dwordx4 v[236:239], v143, s[12:15], s65 offen offset:1888 sc1
    v_exp_f32 v39, v39
    v_cvt_pk_bf16_f32 v24, v32, v33
    v_cvt_pk_bf16_f32 v25, v34, v35
    v_cvt_pk_bf16_f32 v26, v36, v37
    v_exp_f32 v40, v40
    v_cvt_pk_bf16_f32 v27, v38, v39
    v_mfma_f32_32x32x8_bf16 v[48:63], v[250:251], v[16:17], v[48:63]
    v_exp_f32 v41, v41
    v_exp_f32 v42, v42
    v_exp_f32 v43, v43
    v_exp_f32 v44, v44
    v_mfma_f32_32x32x16_bf16 v[64:79], v[208:211], v[24:27], v[64:79]
    v_exp_f32 v45, v45
    v_exp_f32 v46, v46
    v_exp_f32 v47, v47
    v_cvt_pk_bf16_f32 v28, v40, v41
    v_cvt_pk_bf16_f32 v29, v42, v43
    v_cvt_pk_bf16_f32 v30, v44, v45
    v_cvt_pk_bf16_f32 v31, v46, v47
    v_exp_f32 v48, v48
    v_exp_f32 v49, v49
    v_exp_f32 v50, v50
    v_mfma_f32_32x32x16_bf16 v[64:79], v[212:215], v[28:31], v[64:79]
    v_exp_f32 v51, v51
    v_exp_f32 v52, v52
    v_exp_f32 v53, v53
    v_exp_f32 v54, v54
    s_waitcnt vmcnt(5)
    v_mfma_f32_32x32x16_bf16 v[32:47], v[168:171], v[12:15], 0
    v_exp_f32 v55, v55
    v_cvt_pk_bf16_f32 v24, v48, v49
    v_cvt_pk_bf16_f32 v25, v50, v51
    v_cvt_pk_bf16_f32 v26, v52, v53
    v_exp_f32 v56, v56
    v_cvt_pk_bf16_f32 v27, v54, v55
    v_mfma_f32_32x32x8_bf16 v[32:47], v[252:253], v[16:17], v[32:47]
    s_add_u32 s64, s48, 2
    s_and_b32 s64, s64, 7
    v_mad_u32_u24 v7, v11, s64, v10
    s_mul_i32 s64, s64, 1280
    v_add_u32 v6, s64, v9
    v_exp_f32 v57, v57
    v_exp_f32 v58, v58
    v_exp_f32 v59, v59
    v_exp_f32 v60, v60
    v_mfma_f32_32x32x16_bf16 v[64:79], v[216:219], v[24:27], v[64:79]
    v_exp_f32 v61, v61
    v_exp_f32 v62, v62
    v_exp_f32 v63, v63
    v_cvt_pk_bf16_f32 v28, v56, v57
    v_cvt_pk_bf16_f32 v29, v58, v59
    v_cvt_pk_bf16_f32 v30, v60, v61
    v_cvt_pk_bf16_f32 v31, v62, v63
    v_exp_f32 v32, v32
    v_exp_f32 v33, v33
    v_exp_f32 v34, v34
    v_mfma_f32_32x32x16_bf16 v[64:79], v[220:223], v[28:31], v[64:79]
    v_exp_f32 v35, v35
    v_exp_f32 v36, v36
    v_exp_f32 v37, v37
    v_exp_f32 v38, v38
    s_waitcnt vmcnt(2)
    v_mfma_f32_32x32x16_bf16 v[48:63], v[172:175], v[12:15], 0
    ds_read2_b64 v[12:15], v6 offset0:0 offset1:32
    v_exp_f32 v39, v39
    v_cvt_pk_bf16_f32 v24, v32, v33
    v_cvt_pk_bf16_f32 v25, v34, v35
    v_cvt_pk_bf16_f32 v26, v36, v37
    v_exp_f32 v40, v40
    v_cvt_pk_bf16_f32 v27, v38, v39
    v_mfma_f32_32x32x8_bf16 v[48:63], v[254:255], v[16:17], v[48:63]
    ds_read_b64 v[16:17], v7 offset:1024
    v_exp_f32 v41, v41
    v_exp_f32 v42, v42
    v_exp_f32 v43, v43
    v_exp_f32 v44, v44
    v_mfma_f32_32x32x16_bf16 v[64:79], v[224:227], v[24:27], v[64:79]
    v_exp_f32 v45, v45
    v_exp_f32 v46, v46
    v_exp_f32 v47, v47
    v_cvt_pk_bf16_f32 v28, v40, v41
    v_cvt_pk_bf16_f32 v29, v42, v43
    v_cvt_pk_bf16_f32 v30, v44, v45
    v_cvt_pk_bf16_f32 v31, v46, v47
    v_exp_f32 v48, v48
    v_exp_f32 v49, v49
    v_exp_f32 v50, v50
    v_mfma_f32_32x32x16_bf16 v[64:79], v[228:231], v[28:31], v[64:79]
    v_lshrrev_b32 v116, 2, v1
    v_and_b32 v117, 3, v1
    v_lshl_add_u32 v116, v116, 4, v117
    s_lshl_b32 s67, s50, 12
    s_lshl_b32 s66, s49, 5
    s_add_u32 s67, s67, s66
    s_add_u32 s67, s67, 81920
    v_lshl_add_u32 v116, v116, 3, s67
    ds_read_b64_tr_b16 v[96:97], v116
    ds_read_b64_tr_b16 v[98:99], v116 offset:2048
    v_exp_f32 v51, v51
    v_exp_f32 v52, v52
    v_exp_f32 v53, v53
    v_exp_f32 v54, v54
    s_waitcnt lgkmcnt(0)
    v_mfma_f32_32x32x16_bf16 v[32:47], v[144:147], v[12:15], 0
    ds_read_b64_tr_b16 v[100:101], v116 offset:8192
    ds_read_b64_tr_b16 v[102:103], v116 offset:10240
    v_exp_f32 v55, v55
    v_cvt_pk_bf16_f32 v24, v48, v49
    v_cvt_pk_bf16_f32 v25, v50, v51
    v_cvt_pk_bf16_f32 v26, v52, v53
    v_exp_f32 v56, v56
    v_cvt_pk_bf16_f32 v27, v54, v55
    v_mfma_f32_32x32x8_bf16 v[32:47], v[240:241], v[16:17], v[32:47]
    v_exp_f32 v57, v57
    v_exp_f32 v58, v58
    v_exp_f32 v59, v59
    v_exp_f32 v60, v60
    s_waitcnt vmcnt(0)
    v_mfma_f32_32x32x16_bf16 v[64:79], v[232:235], v[24:27], v[64:79]
    ds_read_b64_tr_b16 v[104:105], v116 offset:16384
    ds_read_b64_tr_b16 v[106:107], v116 offset:18432
    v_exp_f32 v61, v61
    v_exp_f32 v62, v62
    v_exp_f32 v63, v63
    v_cvt_pk_bf16_f32 v28, v56, v57
    v_cvt_pk_bf16_f32 v29, v58, v59
    v_cvt_pk_bf16_f32 v30, v60, v61
    v_cvt_pk_bf16_f32 v31, v62, v63
    s_setprio 2
    v_exp_f32 v32, v32
    v_exp_f32 v33, v33
    v_exp_f32 v34, v34
    v_mfma_f32_32x32x16_bf16 v[64:79], v[236:239], v[28:31], v[64:79]
    s_lshl_b32 s58, s20, 12
    s_lshl_b32 s65, s48, 10
    s_add_u32 s58, s58, s65
    s_add_u32 s58, s58, 2097152
    s_waitcnt lgkmcnt(0)
    buffer_store_dwordx4 v[96:99], v2, s[12:15], s58 offen sc1
    v_exp_f32 v35, v35
    v_exp_f32 v36, v36
    v_exp_f32 v37, v37
    v_exp_f32 v38, v38
    v_mfma_f32_32x32x16_bf16 v[48:63], v[148:151], v[12:15], 0
    v_exp_f32 v39, v39
    v_cvt_pk_bf16_f32 v24, v32, v33
    v_cvt_pk_bf16_f32 v25, v34, v35
    v_cvt_pk_bf16_f32 v26, v36, v37
    v_exp_f32 v40, v40
    v_cvt_pk_bf16_f32 v27, v38, v39
    v_mfma_f32_32x32x8_bf16 v[48:63], v[242:243], v[16:17], v[48:63]
    v_exp_f32 v41, v41
    v_exp_f32 v42, v42
    v_exp_f32 v43, v43
    v_exp_f32 v44, v44
    v_pk_add_f32 v[18:19], v[72:73], 0
    v_pk_add_f32 v[20:21], v[74:75], 0
    v_pk_add_f32 v[80:81], v[64:65], 0
    v_pk_add_f32 v[82:83], v[66:67], 0
    v_pk_add_f32 v[84:85], v[68:69], 0
    v_pk_add_f32 v[86:87], v[70:71], 0
    v_mfma_f32_32x32x16_bf16 v[64:79], v[176:179], v[24:27], 0
    ds_write_b128 v8, v[80:83]
    v_exp_f32 v45, v45
    v_exp_f32 v46, v46
    v_exp_f32 v47, v47
    v_cvt_pk_bf16_f32 v28, v40, v41
    v_cvt_pk_bf16_f32 v29, v42, v43
    v_cvt_pk_bf16_f32 v30, v44, v45
    v_cvt_pk_bf16_f32 v31, v46, v47
    s_setprio 1
    v_exp_f32 v48, v48
    v_exp_f32 v49, v49
    v_exp_f32 v50, v50
    v_mfma_f32_32x32x16_bf16 v[64:79], v[180:183], v[28:31], v[64:79]
    s_add_u32 s58, s58, 8192
    buffer_store_dwordx4 v[100:103], v2, s[12:15], s58 offen sc1
    ds_write_b128 v8, v[84:87] offset:1024
    v_exp_f32 v51, v51
    v_exp_f32 v52, v52
    v_exp_f32 v53, v53
    v_exp_f32 v54, v54
    v_mfma_f32_32x32x16_bf16 v[32:47], v[152:155], v[12:15], 0
    ds_write_b128 v8, v[18:21] offset:2048
    v_exp_f32 v55, v55
    v_cvt_pk_bf16_f32 v24, v48, v49
    v_cvt_pk_bf16_f32 v25, v50, v51
    v_cvt_pk_bf16_f32 v26, v52, v53
    v_exp_f32 v56, v56
    v_cvt_pk_bf16_f32 v27, v54, v55
    v_mfma_f32_32x32x8_bf16 v[32:47], v[244:245], v[16:17], v[32:47]
    v_exp_f32 v57, v57
    v_exp_f32 v58, v58
    v_exp_f32 v59, v59
    v_exp_f32 v60, v60
    v_mfma_f32_32x32x16_bf16 v[64:79], v[184:187], v[24:27], v[64:79]
    v_exp_f32 v61, v61
    v_exp_f32 v62, v62
    v_exp_f32 v63, v63
    v_cvt_pk_bf16_f32 v28, v56, v57
    v_cvt_pk_bf16_f32 v29, v58, v59
    v_cvt_pk_bf16_f32 v30, v60, v61
    v_cvt_pk_bf16_f32 v31, v62, v63
    s_setprio 0
    v_exp_f32 v32, v32
    v_exp_f32 v33, v33
    v_exp_f32 v34, v34
    v_mfma_f32_32x32x16_bf16 v[64:79], v[188:191], v[28:31], v[64:79]
    s_cmp_ge_u32 s48, 4
    s_cselect_b64 vcc, -1, 0
    s_add_u32 s58, s58, 8192
    s_cbranch_vccnz L_gd_42
    buffer_store_dwordx4 v[104:107], v2, s[12:15], s58 offen sc1
L_gd_42:
    v_exp_f32 v35, v35
    v_exp_f32 v36, v36
    v_exp_f32 v37, v37
    v_exp_f32 v38, v38
    v_mfma_f32_32x32x16_bf16 v[48:63], v[156:159], v[12:15], 0
    v_exp_f32 v39, v39
    v_cvt_pk_bf16_f32 v24, v32, v33
    v_cvt_pk_bf16_f32 v25, v34, v35
    v_cvt_pk_bf16_f32 v26, v36, v37
    v_exp_f32 v40, v40
    v_cvt_pk_bf16_f32 v27, v38, v39
    v_mfma_f32_32x32x8_bf16 v[48:63], v[246:247], v[16:17], v[48:63]
    v_exp_f32 v41, v41
    v_exp_f32 v42, v42
    v_exp_f32 v43, v43
    v_exp_f32 v44, v44
    v_mfma_f32_32x32x16_bf16 v[64:79], v[192:195], v[24:27], v[64:79]
    v_exp_f32 v45, v45
    v_exp_f32 v46, v46
    v_exp_f32 v47, v47
    v_cvt_pk_bf16_f32 v28, v40, v41
    v_cvt_pk_bf16_f32 v29, v42, v43
    v_cvt_pk_bf16_f32 v30, v44, v45
    v_cvt_pk_bf16_f32 v31, v46, v47
    s_setprio 3
    s_waitcnt lgkmcnt(0)
    s_barrier
    s_add_u32 s64, s48, 2
    s_and_b32 s64, s64, 7
    s_mul_i32 s64, s64, 3072
    s_add_u32 s64, s64, 114688
    v_add_u32 v8, s64, v2
    v_exp_f32 v48, v48
    v_exp_f32 v49, v49
    v_exp_f32 v50, v50
    v_mfma_f32_32x32x16_bf16 v[64:79], v[196:199], v[28:31], v[64:79]
    ds_read_b128 v[80:83], v8
    v_exp_f32 v51, v51
    v_exp_f32 v52, v52
    v_exp_f32 v53, v53
    v_exp_f32 v54, v54
    v_mfma_f32_32x32x16_bf16 v[32:47], v[160:163], v[12:15], 0
    v_mov_b32 v128, -1
    v_mov_b32 v129, -1
    v_mov_b32 v130, -1
    v_mov_b32 v131, -1
    s_lshl_b32 s77, s52, 3
    s_add_u32 s77, s77, s48
    s_mul_i32 s77, s77, 3072
    s_add_u32 s77, s77, s55
    s_add_u32 s77, s77, 163840
    buffer_store_dwordx4 v[128:131], v2, s[12:15], s77 offen sc1
    ds_read_b128 v[84:87], v8 offset:1024
    v_exp_f32 v55, v55
    v_cvt_pk_bf16_f32 v24, v48, v49
    v_cvt_pk_bf16_f32 v25, v50, v51
    v_cvt_pk_bf16_f32 v26, v52, v53
    v_exp_f32 v56, v56
    v_cvt_pk_bf16_f32 v27, v54, v55
    v_mfma_f32_32x32x8_bf16 v[32:47], v[248:249], v[16:17], v[32:47]
    ds_read_b128 v[18:21], v8 offset:2048
    v_exp_f32 v57, v57
    v_exp_f32 v58, v58
    v_exp_f32 v59, v59
    v_exp_f32 v60, v60
    v_mfma_f32_32x32x16_bf16 v[64:79], v[200:203], v[24:27], v[64:79]
    v_exp_f32 v61, v61
    v_exp_f32 v62, v62
    v_exp_f32 v63, v63
    v_cvt_pk_bf16_f32 v28, v56, v57
    v_cvt_pk_bf16_f32 v29, v58, v59
    v_cvt_pk_bf16_f32 v30, v60, v61
    v_cvt_pk_bf16_f32 v31, v62, v63
    v_exp_f32 v32, v32
    v_exp_f32 v33, v33
    v_exp_f32 v34, v34
    v_mfma_f32_32x32x16_bf16 v[64:79], v[204:207], v[28:31], v[64:79]
    v_exp_f32 v35, v35
    v_exp_f32 v36, v36
    v_exp_f32 v37, v37
    v_exp_f32 v38, v38
    v_mfma_f32_32x32x16_bf16 v[48:63], v[164:167], v[12:15], 0
    v_exp_f32 v39, v39
    v_cvt_pk_bf16_f32 v24, v32, v33
    v_cvt_pk_bf16_f32 v25, v34, v35
    v_cvt_pk_bf16_f32 v26, v36, v37
    v_exp_f32 v40, v40
    v_cvt_pk_bf16_f32 v27, v38, v39
    v_mfma_f32_32x32x8_bf16 v[48:63], v[250:251], v[16:17], v[48:63]
    v_exp_f32 v41, v41
    v_exp_f32 v42, v42
    v_exp_f32 v43, v43
    v_exp_f32 v44, v44
    v_mfma_f32_32x32x16_bf16 v[64:79], v[208:211], v[24:27], v[64:79]
    buffer_store_dwordx4 v[128:131], v2, s[12:15], s77 offen offset:1024 sc1
    v_exp_f32 v45, v45
    v_exp_f32 v46, v46
    v_exp_f32 v47, v47
    v_cvt_pk_bf16_f32 v28, v40, v41
    v_cvt_pk_bf16_f32 v29, v42, v43
    v_cvt_pk_bf16_f32 v30, v44, v45
    v_cvt_pk_bf16_f32 v31, v46, v47
    v_exp_f32 v48, v48
    v_exp_f32 v49, v49
    v_exp_f32 v50, v50
    v_mfma_f32_32x32x16_bf16 v[64:79], v[212:215], v[28:31], v[64:79]
    v_exp_f32 v51, v51
    v_exp_f32 v52, v52
    v_exp_f32 v53, v53
    v_exp_f32 v54, v54
    v_mfma_f32_32x32x16_bf16 v[32:47], v[168:171], v[12:15], 0
    v_exp_f32 v55, v55
    v_cvt_pk_bf16_f32 v24, v48, v49
    v_cvt_pk_bf16_f32 v25, v50, v51
    v_cvt_pk_bf16_f32 v26, v52, v53
    v_exp_f32 v56, v56
    v_cvt_pk_bf16_f32 v27, v54, v55
    v_mfma_f32_32x32x8_bf16 v[32:47], v[252:253], v[16:17], v[32:47]
    s_add_u32 s64, s48, 3
    s_and_b32 s64, s64, 7
    v_mad_u32_u24 v7, v11, s64, v10
    s_mul_i32 s64, s64, 1280
    v_add_u32 v6, s64, v9
    v_exp_f32 v57, v57
    v_exp_f32 v58, v58
    v_exp_f32 v59, v59
    v_exp_f32 v60, v60
    v_mfma_f32_32x32x16_bf16 v[64:79], v[216:219], v[24:27], v[64:79]
    v_exp_f32 v61, v61
    v_exp_f32 v62, v62
    v_exp_f32 v63, v63
    v_cvt_pk_bf16_f32 v28, v56, v57
    v_cvt_pk_bf16_f32 v29, v58, v59
    v_cvt_pk_bf16_f32 v30, v60, v61
    v_cvt_pk_bf16_f32 v31, v62, v63
    v_exp_f32 v32, v32
    v_exp_f32 v33, v33
    v_exp_f32 v34, v34
    v_mfma_f32_32x32x16_bf16 v[64:79], v[220:223], v[28:31], v[64:79]
    buffer_store_dwordx4 v[128:131], v2, s[12:15], s77 offen offset:2048 sc1
    v_exp_f32 v35, v35
    v_exp_f32 v36, v36
    v_exp_f32 v37, v37
    v_exp_f32 v38, v38
    v_mfma_f32_32x32x16_bf16 v[48:63], v[172:175], v[12:15], 0
    ds_read2_b64 v[12:15], v6 offset0:0 offset1:32
    v_exp_f32 v39, v39
    v_cvt_pk_bf16_f32 v24, v32, v33
    v_cvt_pk_bf16_f32 v25, v34, v35
    v_cvt_pk_bf16_f32 v26, v36, v37
    v_exp_f32 v40, v40
    v_cvt_pk_bf16_f32 v27, v38, v39
    v_mfma_f32_32x32x8_bf16 v[48:63], v[254:255], v[16:17], v[48:63]
    ds_read_b64 v[16:17], v7 offset:1024
    v_exp_f32 v41, v41
    v_exp_f32 v42, v42
    v_exp_f32 v43, v43
    v_exp_f32 v44, v44
    v_mfma_f32_32x32x16_bf16 v[64:79], v[224:227], v[24:27], v[64:79]
    v_exp_f32 v45, v45
    v_exp_f32 v46, v46
    v_exp_f32 v47, v47
    v_cvt_pk_bf16_f32 v28, v40, v41
    v_cvt_pk_bf16_f32 v29, v42, v43
    v_cvt_pk_bf16_f32 v30, v44, v45
    v_cvt_pk_bf16_f32 v31, v46, v47
    v_exp_f32 v48, v48
    v_exp_f32 v49, v49
    v_exp_f32 v50, v50
    v_mfma_f32_32x32x16_bf16 v[64:79], v[228:231], v[28:31], v[64:79]
    v_exp_f32 v51, v51
    v_exp_f32 v52, v52
    v_exp_f32 v53, v53
    v_exp_f32 v54, v54
    s_waitcnt lgkmcnt(0)
    v_mfma_f32_32x32x16_bf16 v[32:47], v[144:147], v[12:15], 0
    v_exp_f32 v55, v55
    v_cvt_pk_bf16_f32 v24, v48, v49
    v_cvt_pk_bf16_f32 v25, v50, v51
    v_cvt_pk_bf16_f32 v26, v52, v53
    v_exp_f32 v56, v56
    v_cvt_pk_bf16_f32 v27, v54, v55
    v_mfma_f32_32x32x8_bf16 v[32:47], v[240:241], v[16:17], v[32:47]
    v_exp_f32 v57, v57
    v_exp_f32 v58, v58
    v_exp_f32 v59, v59
    v_exp_f32 v60, v60
    v_mfma_f32_32x32x16_bf16 v[64:79], v[232:235], v[24:27], v[64:79]
    v_exp_f32 v61, v61
    v_exp_f32 v62, v62
    v_exp_f32 v63, v63
    v_cvt_pk_bf16_f32 v28, v56, v57
    v_cvt_pk_bf16_f32 v29, v58, v59
    v_cvt_pk_bf16_f32 v30, v60, v61
    v_cvt_pk_bf16_f32 v31, v62, v63
    s_setprio 2
    v_exp_f32 v32, v32
    v_exp_f32 v33, v33
    v_exp_f32 v34, v34
    v_mfma_f32_32x32x16_bf16 v[64:79], v[236:239], v[28:31], v[64:79]
    v_exp_f32 v35, v35
    v_exp_f32 v36, v36
    v_exp_f32 v37, v37
    v_exp_f32 v38, v38
    v_mfma_f32_32x32x16_bf16 v[48:63], v[148:151], v[12:15], 0
    v_exp_f32 v39, v39
    v_cvt_pk_bf16_f32 v24, v32, v33
    v_cvt_pk_bf16_f32 v25, v34, v35
    v_cvt_pk_bf16_f32 v26, v36, v37
    v_exp_f32 v40, v40
    v_cvt_pk_bf16_f32 v27, v38, v39
    v_mfma_f32_32x32x8_bf16 v[48:63], v[242:243], v[16:17], v[48:63]
    v_exp_f32 v41, v41
    v_exp_f32 v42, v42
    v_exp_f32 v43, v43
    v_exp_f32 v44, v44
    v_pk_add_f32 v[18:19], v[72:73], v[18:19]
    v_pk_add_f32 v[20:21], v[74:75], v[20:21]
    v_pk_add_f32 v[80:81], v[64:65], v[80:81]
    v_pk_add_f32 v[82:83], v[66:67], v[82:83]
    v_pk_add_f32 v[84:85], v[68:69], v[84:85]
    v_pk_add_f32 v[86:87], v[70:71], v[86:87]
    v_mfma_f32_32x32x16_bf16 v[64:79], v[176:179], v[24:27], 0
    ds_write_b128 v8, v[80:83]
    v_exp_f32 v45, v45
    v_exp_f32 v46, v46
    v_exp_f32 v47, v47
    v_cvt_pk_bf16_f32 v28, v40, v41
    v_cvt_pk_bf16_f32 v29, v42, v43
    v_cvt_pk_bf16_f32 v30, v44, v45
    v_cvt_pk_bf16_f32 v31, v46, v47
    s_setprio 1
    v_exp_f32 v48, v48
    v_exp_f32 v49, v49
    v_exp_f32 v50, v50
    v_mfma_f32_32x32x16_bf16 v[64:79], v[180:183], v[28:31], v[64:79]
    ds_write_b128 v8, v[84:87] offset:1024
    v_exp_f32 v51, v51
    v_exp_f32 v52, v52
    v_exp_f32 v53, v53
    v_exp_f32 v54, v54
    v_mfma_f32_32x32x16_bf16 v[32:47], v[152:155], v[12:15], 0
    ds_write_b128 v8, v[18:21] offset:2048
    v_exp_f32 v55, v55
    v_cvt_pk_bf16_f32 v24, v48, v49
    v_cvt_pk_bf16_f32 v25, v50, v51
    v_cvt_pk_bf16_f32 v26, v52, v53
    v_exp_f32 v56, v56
    v_cvt_pk_bf16_f32 v27, v54, v55
    v_mfma_f32_32x32x8_bf16 v[32:47], v[244:245], v[16:17], v[32:47]
    v_exp_f32 v57, v57
    v_exp_f32 v58, v58
    v_exp_f32 v59, v59
    v_exp_f32 v60, v60
    v_mfma_f32_32x32x16_bf16 v[64:79], v[184:187], v[24:27], v[64:79]
    v_exp_f32 v61, v61
    v_exp_f32 v62, v62
    v_exp_f32 v63, v63
    v_cvt_pk_bf16_f32 v28, v56, v57
    v_cvt_pk_bf16_f32 v29, v58, v59
    v_cvt_pk_bf16_f32 v30, v60, v61
    v_cvt_pk_bf16_f32 v31, v62, v63
    s_setprio 0
    v_exp_f32 v32, v32
    v_exp_f32 v33, v33
    v_exp_f32 v34, v34
    v_mfma_f32_32x32x16_bf16 v[64:79], v[188:191], v[28:31], v[64:79]
    v_exp_f32 v35, v35
    v_exp_f32 v36, v36
    v_exp_f32 v37, v37
    v_exp_f32 v38, v38
    v_mfma_f32_32x32x16_bf16 v[48:63], v[156:159], v[12:15], 0
    v_exp_f32 v39, v39
    v_cvt_pk_bf16_f32 v24, v32, v33
    v_cvt_pk_bf16_f32 v25, v34, v35
    v_cvt_pk_bf16_f32 v26, v36, v37
    v_exp_f32 v40, v40
    v_cvt_pk_bf16_f32 v27, v38, v39
    v_mfma_f32_32x32x8_bf16 v[48:63], v[246:247], v[16:17], v[48:63]
    v_exp_f32 v41, v41
    v_exp_f32 v42, v42
    v_exp_f32 v43, v43
    v_exp_f32 v44, v44
    v_mfma_f32_32x32x16_bf16 v[64:79], v[192:195], v[24:27], v[64:79]
    v_exp_f32 v45, v45
    v_exp_f32 v46, v46
    v_exp_f32 v47, v47
    v_cvt_pk_bf16_f32 v28, v40, v41
    v_cvt_pk_bf16_f32 v29, v42, v43
    v_cvt_pk_bf16_f32 v30, v44, v45
    v_cvt_pk_bf16_f32 v31, v46, v47
    s_setprio 3
    s_waitcnt vmcnt(3)
    s_waitcnt lgkmcnt(0)
    s_barrier
    s_add_u32 s64, s48, 3
    s_and_b32 s64, s64, 7
    s_mul_i32 s64, s64, 3072
    s_add_u32 s64, s64, 114688
    v_add_u32 v8, s64, v2
    v_exp_f32 v48, v48
    v_exp_f32 v49, v49
    v_exp_f32 v50, v50
    v_mfma_f32_32x32x16_bf16 v[64:79], v[196:199], v[28:31], v[64:79]
    ds_read_b128 v[80:83], v8
    v_exp_f32 v51, v51
    v_exp_f32 v52, v52
    v_exp_f32 v53, v53
    v_exp_f32 v54, v54
    v_mfma_f32_32x32x16_bf16 v[32:47], v[160:163], v[12:15], 0
    s_cmp_eq_u32 s48, 0
    s_cbranch_scc1 L_flags
L_flags_r:
    ds_read_b128 v[84:87], v8 offset:1024
    v_exp_f32 v55, v55
    v_cvt_pk_bf16_f32 v24, v48, v49
    v_cvt_pk_bf16_f32 v25, v50, v51
    v_cvt_pk_bf16_f32 v26, v52, v53
    v_exp_f32 v56, v56
    v_cvt_pk_bf16_f32 v27, v54, v55
    v_mfma_f32_32x32x8_bf16 v[32:47], v[248:249], v[16:17], v[32:47]
    ds_read_b128 v[18:21], v8 offset:2048
    v_exp_f32 v57, v57
    v_exp_f32 v58, v58
    v_exp_f32 v59, v59
    v_exp_f32 v60, v60
    v_mfma_f32_32x32x16_bf16 v[64:79], v[200:203], v[24:27], v[64:79]
    v_exp_f32 v61, v61
    v_exp_f32 v62, v62
    v_exp_f32 v63, v63
    v_cvt_pk_bf16_f32 v28, v56, v57
    v_cvt_pk_bf16_f32 v29, v58, v59
    v_cvt_pk_bf16_f32 v30, v60, v61
    v_cvt_pk_bf16_f32 v31, v62, v63
    v_exp_f32 v32, v32
    v_exp_f32 v33, v33
    v_exp_f32 v34, v34
    v_mfma_f32_32x32x16_bf16 v[64:79], v[204:207], v[28:31], v[64:79]
    v_exp_f32 v35, v35
    v_exp_f32 v36, v36
    v_exp_f32 v37, v37
    v_exp_f32 v38, v38
    v_mfma_f32_32x32x16_bf16 v[48:63], v[164:167], v[12:15], 0
    buffer_store_dwordx4 v[128:131], v2, s[12:15], s17 offen sc1
    v_exp_f32 v39, v39
    v_cvt_pk_bf16_f32 v24, v32, v33
    v_cvt_pk_bf16_f32 v25, v34, v35
    v_cvt_pk_bf16_f32 v26, v36, v37
    v_exp_f32 v40, v40
    v_cvt_pk_bf16_f32 v27, v38, v39
    v_mfma_f32_32x32x8_bf16 v[48:63], v[250:251], v[16:17], v[48:63]
    v_exp_f32 v41, v41
    v_exp_f32 v42, v42
    v_exp_f32 v43, v43
    v_exp_f32 v44, v44
    v_mfma_f32_32x32x16_bf16 v[64:79], v[208:211], v[24:27], v[64:79]
    v_exp_f32 v45, v45
    v_exp_f32 v46, v46
    v_exp_f32 v47, v47
    v_cvt_pk_bf16_f32 v28, v40, v41
    v_cvt_pk_bf16_f32 v29, v42, v43
    v_cvt_pk_bf16_f32 v30, v44, v45
    v_cvt_pk_bf16_f32 v31, v46, v47
    v_exp_f32 v48, v48
    v_exp_f32 v49, v49
    v_exp_f32 v50, v50
    v_mfma_f32_32x32x16_bf16 v[64:79], v[212:215], v[28:31], v[64:79]
    v_exp_f32 v51, v51
    v_exp_f32 v52, v52
    v_exp_f32 v53, v53
    v_exp_f32 v54, v54
    v_mfma_f32_32x32x16_bf16 v[32:47], v[168:171], v[12:15], 0
    s_sub_u32 s65, s17, 81920
    buffer_store_dwordx4 v[128:131], v2, s[12:15], s65 offen sc1
    v_exp_f32 v55, v55
    v_cvt_pk_bf16_f32 v24, v48, v49
    v_cvt_pk_bf16_f32 v25, v50, v51
    v_cvt_pk_bf16_f32 v26, v52, v53
    v_exp_f32 v56, v56
    v_cvt_pk_bf16_f32 v27, v54, v55
    v_mfma_f32_32x32x8_bf16 v[32:47], v[252:253], v[16:17], v[32:47]
    s_add_u32 s64, s48, 4
    s_and_b32 s64, s64, 7
    v_mad_u32_u24 v7, v11, s64, v10
    s_mul_i32 s64, s64, 1280
    v_add_u32 v6, s64, v9
    v_exp_f32 v57, v57
    v_exp_f32 v58, v58
    v_exp_f32 v59, v59
    v_exp_f32 v60, v60
    v_mfma_f32_32x32x16_bf16 v[64:79], v[216:219], v[24:27], v[64:79]
    v_exp_f32 v61, v61
    v_exp_f32 v62, v62
    v_exp_f32 v63, v63
    v_cvt_pk_bf16_f32 v28, v56, v57
    v_cvt_pk_bf16_f32 v29, v58, v59
    v_cvt_pk_bf16_f32 v30, v60, v61
    v_cvt_pk_bf16_f32 v31, v62, v63
    v_exp_f32 v32, v32
    v_exp_f32 v33, v33
    v_exp_f32 v34, v34
    v_mfma_f32_32x32x16_bf16 v[64:79], v[220:223], v[28:31], v[64:79]
    v_exp_f32 v35, v35
    v_exp_f32 v36, v36
    v_exp_f32 v37, v37
    v_exp_f32 v38, v38
    v_mfma_f32_32x32x16_bf16 v[48:63], v[172:175], v[12:15], 0
    s_and_b32 s65, s18, 8
    s_lshl_b32 s66, s65, 6
    s_sub_u32 s65, s18, s65
    s_add_u32 s65, s65, s66
    s_lshl_b32 s66, s50, 8
    s_add_u32 s65, s65, s66
    s_sub_u32 s65, s65, 81920
    v_lshrrev_b32 v118, 4, v1
    v_mul_u32_u24 v118, 81664, v118
    v_add_u32 v118, v118, v2
    s_mov_b32 exec_hi, 0
    buffer_store_dwordx4 v[128:131], v118, s[12:15], s65 offen sc1
    s_mov_b64 exec, -1
    ds_read2_b64 v[12:15], v6 offset0:0 offset1:32
    v_exp_f32 v39, v39
    v_cvt_pk_bf16_f32 v24, v32, v33
    v_cvt_pk_bf16_f32 v25, v34, v35
    v_cvt_pk_bf16_f32 v26, v36, v37
    v_exp_f32 v40, v40
    v_cvt_pk_bf16_f32 v27, v38, v39
    v_mfma_f32_32x32x8_bf16 v[48:63], v[254:255], v[16:17], v[48:63]
    ds_read_b64 v[16:17], v7 offset:1024
    v_exp_f32 v41, v41
    v_exp_f32 v42, v42
    v_exp_f32 v43, v43
    v_exp_f32 v44, v44
    v_mfma_f32_32x32x16_bf16 v[64:79], v[224:227], v[24:27], v[64:79]
    v_exp_f32 v45, v45
    v_exp_f32 v46, v46
    v_exp_f32 v47, v47
    v_cvt_pk_bf16_f32 v28, v40, v41
    v_cvt_pk_bf16_f32 v29, v42, v43
    v_cvt_pk_bf16_f32 v30, v44, v45
    v_cvt_pk_bf16_f32 v31, v46, v47
    v_exp_f32 v48, v48
    v_exp_f32 v49, v49
    v_exp_f32 v50, v50
    v_mfma_f32_32x32x16_bf16 v[64:79], v[228:231], v[28:31], v[64:79]
    v_exp_f32 v51, v51
    v_exp_f32 v52, v52
    v_exp_f32 v53, v53
    v_exp_f32 v54, v54
    s_waitcnt lgkmcnt(0)
    v_mfma_f32_32x32x16_bf16 v[32:47], v[144:147], v[12:15], 0
    v_exp_f32 v55, v55
    v_cvt_pk_bf16_f32 v24, v48, v49
    v_cvt_pk_bf16_f32 v25, v50, v51
    v_cvt_pk_bf16_f32 v26, v52, v53
    v_exp_f32 v56, v56
    v_cvt_pk_bf16_f32 v27, v54, v55
    v_mfma_f32_32x32x8_bf16 v[32:47], v[240:241], v[16:17], v[32:47]
    v_exp_f32 v57, v57
    v_exp_f32 v58, v58
    v_exp_f32 v59, v59
    v_exp_f32 v60, v60
    v_mfma_f32_32x32x16_bf16 v[64:79], v[232:235], v[24:27], v[64:79]
    v_exp_f32 v61, v61
    v_exp_f32 v62, v62
    v_exp_f32 v63, v63
    v_cvt_pk_bf16_f32 v28, v56, v57
    v_cvt_pk_bf16_f32 v29, v58, v59
    v_cvt_pk_bf16_f32 v30, v60, v61
    v_cvt_pk_bf16_f32 v31, v62, v63
    s_setprio 2
    v_exp_f32 v32, v32
    v_exp_f32 v33, v33
    v_exp_f32 v34, v34
    v_mfma_f32_32x32x16_bf16 v[64:79], v[236:239], v[28:31], v[64:79]
    v_exp_f32 v35, v35
    v_exp_f32 v36, v36
    v_exp_f32 v37, v37
    v_exp_f32 v38, v38
    v_mfma_f32_32x32x16_bf16 v[48:63], v[148:151], v[12:15], 0
    v_exp_f32 v39, v39
    v_cvt_pk_bf16_f32 v24, v32, v33
    v_cvt_pk_bf16_f32 v25, v34, v35
    v_cvt_pk_bf16_f32 v26, v36, v37
    v_exp_f32 v40, v40
    v_cvt_pk_bf16_f32 v27, v38, v39
    v_mfma_f32_32x32x8_bf16 v[48:63], v[242:243], v[16:17], v[48:63]
    v_exp_f32 v41, v41
    v_exp_f32 v42, v42
    v_exp_f32 v43, v43
    v_exp_f32 v44, v44
    v_pk_add_f32 v[18:19], v[72:73], v[18:19]
    v_pk_add_f32 v[20:21], v[74:75], v[20:21]
    v_pk_add_f32 v[80:81], v[64:65], v[80:81]
    v_pk_add_f32 v[82:83], v[66:67], v[82:83]
    v_pk_add_f32 v[84:85], v[68:69], v[84:85]
    v_pk_add_f32 v[86:87], v[70:71], v[86:87]
    v_mfma_f32_32x32x16_bf16 v[64:79], v[176:179], v[24:27], 0
    ds_write_b128 v8, v[80:83]
    v_exp_f32 v45, v45
    v_exp_f32 v46, v46
    v_exp_f32 v47, v47
    v_cvt_pk_bf16_f32 v28, v40, v41
    v_cvt_pk_bf16_f32 v29, v42, v43
    v_cvt_pk_bf16_f32 v30, v44, v45
    v_cvt_pk_bf16_f32 v31, v46, v47
    s_setprio 1
    v_exp_f32 v48, v48
    v_exp_f32 v49, v49
    v_exp_f32 v50, v50
    v_mfma_f32_32x32x16_bf16 v[64:79], v[180:183], v[28:31], v[64:79]
    ds_write_b128 v8, v[84:87] offset:1024
    v_exp_f32 v51, v51
    v_exp_f32 v52, v52
    v_exp_f32 v53, v53
    v_exp_f32 v54, v54
    v_mfma_f32_32x32x16_bf16 v[32:47], v[152:155], v[12:15], 0
    ds_write_b128 v8, v[18:21] offset:2048
    v_exp_f32 v55, v55
    v_cvt_pk_bf16_f32 v24, v48, v49
    v_cvt_pk_bf16_f32 v25, v50, v51
    v_cvt_pk_bf16_f32 v26, v52, v53
    v_exp_f32 v56, v56
    v_cvt_pk_bf16_f32 v27, v54, v55
    v_mfma_f32_32x32x8_bf16 v[32:47], v[244:245], v[16:17], v[32:47]
    v_exp_f32 v57, v57
    v_exp_f32 v58, v58
    v_exp_f32 v59, v59
    v_exp_f32 v60, v60
    v_mfma_f32_32x32x16_bf16 v[64:79], v[184:187], v[24:27], v[64:79]
    v_exp_f32 v61, v61
    v_exp_f32 v62, v62
    v_exp_f32 v63, v63
    v_cvt_pk_bf16_f32 v28, v56, v57
    v_cvt_pk_bf16_f32 v29, v58, v59
    v_cvt_pk_bf16_f32 v30, v60, v61
    v_cvt_pk_bf16_f32 v31, v62, v63
    s_setprio 0
    v_exp_f32 v32, v32
    v_exp_f32 v33, v33
    v_exp_f32 v34, v34
    v_mfma_f32_32x32x16_bf16 v[64:79], v[188:191], v[28:31], v[64:79]
    v_exp_f32 v35, v35
    v_exp_f32 v36, v36
    v_exp_f32 v37, v37
    v_exp_f32 v38, v38
    v_mfma_f32_32x32x16_bf16 v[48:63], v[156:159], v[12:15], 0
    v_exp_f32 v39, v39
    v_cvt_pk_bf16_f32 v24, v32, v33
    v_cvt_pk_bf16_f32 v25, v34, v35
    v_cvt_pk_bf16_f32 v26, v36, v37
    v_exp_f32 v40, v40
    v_cvt_pk_bf16_f32 v27, v38, v39
    v_mfma_f32_32x32x8_bf16 v[48:63], v[246:247], v[16:17], v[48:63]
    v_exp_f32 v41, v41
    v_exp_f32 v42, v42
    v_exp_f32 v43, v43
    v_exp_f32 v44, v44
    v_mfma_f32_32x32x16_bf16 v[64:79], v[192:195], v[24:27], v[64:79]
    v_exp_f32 v45, v45
    v_exp_f32 v46, v46
    v_exp_f32 v47, v47
    v_cvt_pk_bf16_f32 v28, v40, v41
    v_cvt_pk_bf16_f32 v29, v42, v43
    v_cvt_pk_bf16_f32 v30, v44, v45
    v_cvt_pk_bf16_f32 v31, v46, v47
    s_setprio 3
    s_waitcnt lgkmcnt(0)
    s_barrier
    s_add_u32 s64, s48, 4
    s_and_b32 s64, s64, 7
    s_mul_i32 s64, s64, 3072
    s_add_u32 s64, s64, 114688
    v_add_u32 v8, s64, v2
    v_exp_f32 v48, v48
    v_exp_f32 v49, v49
    v_exp_f32 v50, v50
    v_mfma_f32_32x32x16_bf16 v[64:79], v[196:199], v[28:31], v[64:79]
    ds_read_b128 v[80:83], v8
    v_exp_f32 v51, v51
    v_exp_f32 v52, v52
    v_exp_f32 v53, v53
    v_exp_f32 v54, v54
    v_mfma_f32_32x32x16_bf16 v[32:47], v[160:163], v[12:15], 0
    ds_read_b128 v[84:87], v8 offset:1024
    v_exp_f32 v55, v55
    v_cvt_pk_bf16_f32 v24, v48, v49
    v_cvt_pk_bf16_f32 v25, v50, v51
    v_cvt_pk_bf16_f32 v26, v52, v53
    v_exp_f32 v56, v56
    v_cvt_pk_bf16_f32 v27, v54, v55
    v_mfma_f32_32x32x8_bf16 v[32:47], v[248:249], v[16:17], v[32:47]
    ds_read_b128 v[18:21], v8 offset:2048
    v_exp_f32 v57, v57
    v_exp_f32 v58, v58
    v_exp_f32 v59, v59
    v_exp_f32 v60, v60
    v_mfma_f32_32x32x16_bf16 v[64:79], v[200:203], v[24:27], v[64:79]
    v_exp_f32 v61, v61
    v_exp_f32 v62, v62
    v_exp_f32 v63, v63
    v_cvt_pk_bf16_f32 v28, v56, v57
    v_cvt_pk_bf16_f32 v29, v58, v59
    v_cvt_pk_bf16_f32 v30, v60, v61
    v_cvt_pk_bf16_f32 v31, v62, v63
    v_exp_f32 v32, v32
    v_exp_f32 v33, v33
    v_exp_f32 v34, v34
    v_mfma_f32_32x32x16_bf16 v[64:79], v[204:207], v[28:31], v[64:79]
    v_min_u32 v140, 59, v1
    v_lshlrev_b32 v140, 2, v140
    v_min_u32 v141, 784, v2
    s_mul_i32 s65, s52, 240
    s_add_u32 s65, s65, 8192
    buffer_load_dword v136, v140, s[12:15], s65 offen sc1
    s_mul_i32 s65, s48, 240
    s_add_u32 s65, s65, 10112
    buffer_load_dword v137, v140, s[12:15], s65 offen sc1
    s_movk_i32 s65, 12032
    buffer_load_dwordx4 v[132:135], v141, s[12:15], s65 offen sc1
    v_exp_f32 v35, v35
    v_exp_f32 v36, v36
    v_exp_f32 v37, v37
    v_exp_f32 v38, v38
    v_mfma_f32_32x32x16_bf16 v[48:63], v[164:167], v[12:15], 0
    v_exp_f32 v39, v39
    v_cvt_pk_bf16_f32 v24, v32, v33
    v_cvt_pk_bf16_f32 v25, v34, v35
    v_cvt_pk_bf16_f32 v26, v36, v37
    v_exp_f32 v40, v40
    v_cvt_pk_bf16_f32 v27, v38, v39
    v_mfma_f32_32x32x8_bf16 v[48:63], v[250:251], v[16:17], v[48:63]
    v_exp_f32 v41, v41
    v_exp_f32 v42, v42
    v_exp_f32 v43, v43
    v_exp_f32 v44, v44
    v_mfma_f32_32x32x16_bf16 v[64:79], v[208:211], v[24:27], v[64:79]
    v_exp_f32 v45, v45
    v_exp_f32 v46, v46
    v_exp_f32 v47, v47
    v_cvt_pk_bf16_f32 v28, v40, v41
    v_cvt_pk_bf16_f32 v29, v42, v43
    v_cvt_pk_bf16_f32 v30, v44, v45
    v_cvt_pk_bf16_f32 v31, v46, v47
    v_exp_f32 v48, v48
    v_exp_f32 v49, v49
    v_exp_f32 v50, v50
    v_mfma_f32_32x32x16_bf16 v[64:79], v[212:215], v[28:31], v[64:79]
    v_exp_f32 v51, v51
    v_exp_f32 v52, v52
    v_exp_f32 v53, v53
    v_exp_f32 v54, v54
    v_mfma_f32_32x32x16_bf16 v[32:47], v[168:171], v[12:15], 0
    v_exp_f32 v55, v55
    v_cvt_pk_bf16_f32 v24, v48, v49
    v_cvt_pk_bf16_f32 v25, v50, v51
    v_cvt_pk_bf16_f32 v26, v52, v53
    v_exp_f32 v56, v56
    v_cvt_pk_bf16_f32 v27, v54, v55
    v_mfma_f32_32x32x8_bf16 v[32:47], v[252:253], v[16:17], v[32:47]
    s_add_u32 s64, s48, 5
    s_and_b32 s64, s64, 7
    v_mad_u32_u24 v7, v11, s64, v10
    s_mul_i32 s64, s64, 1280
    v_add_u32 v6, s64, v9
    v_exp_f32 v57, v57
    v_exp_f32 v58, v58
    v_exp_f32 v59, v59
    v_exp_f32 v60, v60
    v_mfma_f32_32x32x16_bf16 v[64:79], v[216:219], v[24:27], v[64:79]
    v_exp_f32 v61, v61
    v_exp_f32 v62, v62
    v_exp_f32 v63, v63
    v_cvt_pk_bf16_f32 v28, v56, v57
    v_cvt_pk_bf16_f32 v29, v58, v59
    v_cvt_pk_bf16_f32 v30, v60, v61
    v_cvt_pk_bf16_f32 v31, v62, v63
    v_exp_f32 v32, v32
    v_exp_f32 v33, v33
    v_exp_f32 v34, v34
    v_mfma_f32_32x32x16_bf16 v[64:79], v[220:223], v[28:31], v[64:79]
    v_exp_f32 v35, v35
    v_exp_f32 v36, v36
    v_exp_f32 v37, v37
    v_exp_f32 v38, v38
    v_mfma_f32_32x32x16_bf16 v[48:63], v[172:175], v[12:15], 0
    ds_read2_b64 v[12:15], v6 offset0:0 offset1:32
    v_exp_f32 v39, v39
    v_cvt_pk_bf16_f32 v24, v32, v33
    v_cvt_pk_bf16_f32 v25, v34, v35
    v_cvt_pk_bf16_f32 v26, v36, v37
    v_exp_f32 v40, v40
    v_cvt_pk_bf16_f32 v27, v38, v39
    v_mfma_f32_32x32x8_bf16 v[48:63], v[254:255], v[16:17], v[48:63]
    ds_read_b64 v[16:17], v7 offset:1024
    v_exp_f32 v41, v41
    v_exp_f32 v42, v42
    v_exp_f32 v43, v43
    v_exp_f32 v44, v44
    v_mfma_f32_32x32x16_bf16 v[64:79], v[224:227], v[24:27], v[64:79]
    v_exp_f32 v45, v45
    v_exp_f32 v46, v46
    v_exp_f32 v47, v47
    v_cvt_pk_bf16_f32 v28, v40, v41
    v_cvt_pk_bf16_f32 v29, v42, v43
    v_cvt_pk_bf16_f32 v30, v44, v45
    v_cvt_pk_bf16_f32 v31, v46, v47
    v_exp_f32 v48, v48
    v_exp_f32 v49, v49
    v_exp_f32 v50, v50
    v_mfma_f32_32x32x16_bf16 v[64:79], v[228:231], v[28:31], v[64:79]
    s_waitcnt vmcnt(0)
    v_max3_u32 v138, v136, v137, s54
    v_min3_u32 v136, v136, v137, s54
    v_max3_u32 v138, v138, v132, v133
    v_min3_u32 v136, v136, v132, v133
    v_max3_u32 v138, v138, v134, v135
    v_min3_u32 v136, v136, v134, v135
    v_cmp_ne_u32 vcc, v136, v138
    s_cbranch_vccnz L_poll
L_poll_r:
    v_exp_f32 v51, v51
    v_exp_f32 v52, v52
    v_exp_f32 v53, v53
    v_exp_f32 v54, v54
    s_waitcnt lgkmcnt(0)
    v_mfma_f32_32x32x16_bf16 v[32:47], v[144:147], v[12:15], 0
    s_mul_i32 s75, s48, -204800
    s_add_u32 s75, s75, 1966080
    s_add_u32 s75, s75, s42
    s_mul_i32 s58, s48, 5120
    s_mov_b32 m0, s58
    s_nop 0
    buffer_load_dwordx4 v2, s[12:15], s75 offen offset:0 sc1 lds
    v_exp_f32 v55, v55
    v_cvt_pk_bf16_f32 v24, v48, v49
    v_cvt_pk_bf16_f32 v25, v50, v51
    v_cvt_pk_bf16_f32 v26, v52, v53
    v_exp_f32 v56, v56
    v_cvt_pk_bf16_f32 v27, v54, v55
    v_mfma_f32_32x32x8_bf16 v[32:47], v[240:241], v[16:17], v[32:47]
    v_exp_f32 v57, v57
    v_exp_f32 v58, v58
    v_exp_f32 v59, v59
    v_exp_f32 v60, v60
    v_mfma_f32_32x32x16_bf16 v[64:79], v[232:235], v[24:27], v[64:79]
    buffer_load_dwordx4 v2, s[12:15], s75 offen offset:1024 sc1 lds
    v_exp_f32 v61, v61
    v_exp_f32 v62, v62
    v_exp_f32 v63, v63
    v_cvt_pk_bf16_f32 v28, v56, v57
    v_cvt_pk_bf16_f32 v29, v58, v59
    v_cvt_pk_bf16_f32 v30, v60, v61
    v_cvt_pk_bf16_f32 v31, v62, v63
    s_setprio 2
    v_exp_f32 v32, v32
    v_exp_f32 v33, v33
    v_exp_f32 v34, v34
    v_mfma_f32_32x32x16_bf16 v[64:79], v[236:239], v[28:31], v[64:79]
    buffer_load_dwordx4 v2, s[12:15], s75 offen offset:2048 sc1 lds
    v_exp_f32 v35, v35
    v_exp_f32 v36, v36
    v_exp_f32 v37, v37
    v_exp_f32 v38, v38
    v_mfma_f32_32x32x16_bf16 v[48:63], v[148:151], v[12:15], 0
    v_exp_f32 v39, v39
    v_cvt_pk_bf16_f32 v24, v32, v33
    v_cvt_pk_bf16_f32 v25, v34, v35
    v_cvt_pk_bf16_f32 v26, v36, v37
    v_exp_f32 v40, v40
    v_cvt_pk_bf16_f32 v27, v38, v39
    v_mfma_f32_32x32x8_bf16 v[48:63], v[242:243], v[16:17], v[48:63]
    v_exp_f32 v41, v41
    v_exp_f32 v42, v42
    v_exp_f32 v43, v43
    v_exp_f32 v44, v44
    v_pk_add_f32 v[18:19], v[72:73], v[18:19]
    v_pk_add_f32 v[20:21], v[74:75], v[20:21]
    v_pk_add_f32 v[80:81], v[64:65], v[80:81]
    v_pk_add_f32 v[82:83], v[66:67], v[82:83]
    v_pk_add_f32 v[84:85], v[68:69], v[84:85]
    v_pk_add_f32 v[86:87], v[70:71], v[86:87]
    v_mfma_f32_32x32x16_bf16 v[64:79], v[176:179], v[24:27], 0
    buffer_load_dwordx4 v2, s[12:15], s75 offen offset:3072 sc1 lds
    ds_write_b128 v8, v[80:83]
    v_exp_f32 v45, v45
    v_exp_f32 v46, v46
    v_exp_f32 v47, v47
    v_cvt_pk_bf16_f32 v28, v40, v41
    v_cvt_pk_bf16_f32 v29, v42, v43
    v_cvt_pk_bf16_f32 v30, v44, v45
    v_cvt_pk_bf16_f32 v31, v46, v47
    s_setprio 1
    v_exp_f32 v48, v48
    v_exp_f32 v49, v49
    v_exp_f32 v50, v50
    v_mfma_f32_32x32x16_bf16 v[64:79], v[180:183], v[28:31], v[64:79]
    ds_write_b128 v8, v[84:87] offset:1024
    v_exp_f32 v51, v51
    v_exp_f32 v52, v52
    v_exp_f32 v53, v53
    v_exp_f32 v54, v54
    v_mfma_f32_32x32x16_bf16 v[32:47], v[152:155], v[12:15], 0
    s_add_u32 m0, m0, 4096
    s_add_u32 s65, s75, 4096
    buffer_load_dwordx4 v2, s[12:15], s65 offen offset:0 sc1 lds
    ds_write_b128 v8, v[18:21] offset:2048
    v_exp_f32 v55, v55
    v_cvt_pk_bf16_f32 v24, v48, v49
    v_cvt_pk_bf16_f32 v25, v50, v51
    v_cvt_pk_bf16_f32 v26, v52, v53
    v_exp_f32 v56, v56
    v_cvt_pk_bf16_f32 v27, v54, v55
    v_mfma_f32_32x32x8_bf16 v[32:47], v[244:245], v[16:17], v[32:47]
    v_exp_f32 v57, v57
    v_exp_f32 v58, v58
    v_exp_f32 v59, v59
    v_exp_f32 v60, v60
    v_mfma_f32_32x32x16_bf16 v[64:79], v[184:187], v[24:27], v[64:79]
    v_exp_f32 v61, v61
    v_exp_f32 v62, v62
    v_exp_f32 v63, v63
    v_cvt_pk_bf16_f32 v28, v56, v57
    v_cvt_pk_bf16_f32 v29, v58, v59
    v_cvt_pk_bf16_f32 v30, v60, v61
    v_cvt_pk_bf16_f32 v31, v62, v63
    s_setprio 0
    v_exp_f32 v32, v32
    v_exp_f32 v33, v33
    v_exp_f32 v34, v34
    v_mfma_f32_32x32x16_bf16 v[64:79], v[188:191], v[28:31], v[64:79]
    s_add_u32 s75, s75, 327680
    s_add_u32 m0, s58, 40960
    s_nop 0
    buffer_load_dwordx4 v2, s[12:15], s75 offen offset:0 sc1 lds
    v_exp_f32 v35, v35
    v_exp_f32 v36, v36
    v_exp_f32 v37, v37
    v_exp_f32 v38, v38
    v_mfma_f32_32x32x16_bf16 v[48:63], v[156:159], v[12:15], 0
    v_exp_f32 v39, v39
    v_cvt_pk_bf16_f32 v24, v32, v33
    v_cvt_pk_bf16_f32 v25, v34, v35
    v_cvt_pk_bf16_f32 v26, v36, v37
    v_exp_f32 v40, v40
    v_cvt_pk_bf16_f32 v27, v38, v39
    v_mfma_f32_32x32x8_bf16 v[48:63], v[246:247], v[16:17], v[48:63]
    v_exp_f32 v41, v41
    v_exp_f32 v42, v42
    v_exp_f32 v43, v43
    v_exp_f32 v44, v44
    v_mfma_f32_32x32x16_bf16 v[64:79], v[192:195], v[24:27], v[64:79]
    v_exp_f32 v45, v45
    v_exp_f32 v46, v46
    v_exp_f32 v47, v47
    v_cvt_pk_bf16_f32 v28, v40, v41
    v_cvt_pk_bf16_f32 v29, v42, v43
    v_cvt_pk_bf16_f32 v30, v44, v45
    v_cvt_pk_bf16_f32 v31, v46, v47
    s_setprio 3
    s_waitcnt lgkmcnt(0)
    s_barrier
    s_add_u32 s64, s48, 5
    s_and_b32 s64, s64, 7
    s_mul_i32 s64, s64, 3072
    s_add_u32 s64, s64, 114688
    v_add_u32 v8, s64, v2
    v_exp_f32 v48, v48
    v_exp_f32 v49, v49
    v_exp_f32 v50, v50
    v_mfma_f32_32x32x16_bf16 v[64:79], v[196:199], v[28:31], v[64:79]
    ds_read_b128 v[80:83], v8
    v_exp_f32 v51, v51
    v_exp_f32 v52, v52
    v_exp_f32 v53, v53
    v_exp_f32 v54, v54
    v_mfma_f32_32x32x16_bf16 v[32:47], v[160:163], v[12:15], 0
    s_cmp_eq_u32 s48, 0
    s_cbranch_scc1 L_gflag
L_gflag_r:
    ds_read_b128 v[84:87], v8 offset:1024
    v_exp_f32 v55, v55
    v_cvt_pk_bf16_f32 v24, v48, v49
    v_cvt_pk_bf16_f32 v25, v50, v51
    v_cvt_pk_bf16_f32 v26, v52, v53
    v_exp_f32 v56, v56
    v_cvt_pk_bf16_f32 v27, v54, v55
    v_mfma_f32_32x32x8_bf16 v[32:47], v[248:249], v[16:17], v[32:47]
    ds_read_b128 v[18:21], v8 offset:2048
    v_exp_f32 v57, v57
    v_exp_f32 v58, v58
    v_exp_f32 v59, v59
    v_exp_f32 v60, v60
    v_mfma_f32_32x32x16_bf16 v[64:79], v[200:203], v[24:27], v[64:79]
    buffer_load_dwordx4 v2, s[12:15], s75 offen offset:1024 sc1 lds
    v_exp_f32 v61, v61
    v_exp_f32 v62, v62
    v_exp_f32 v63, v63
    v_cvt_pk_bf16_f32 v28, v56, v57
    v_cvt_pk_bf16_f32 v29, v58, v59
    v_cvt_pk_bf16_f32 v30, v60, v61
    v_cvt_pk_bf16_f32 v31, v62, v63
    v_exp_f32 v32, v32
    v_exp_f32 v33, v33
    v_exp_f32 v34, v34
    v_mfma_f32_32x32x16_bf16 v[64:79], v[204:207], v[28:31], v[64:79]
    v_exp_f32 v35, v35
    v_exp_f32 v36, v36
    v_exp_f32 v37, v37
    v_exp_f32 v38, v38
    v_mfma_f32_32x32x16_bf16 v[48:63], v[164:167], v[12:15], 0
    buffer_load_dwordx4 v2, s[12:15], s75 offen offset:2048 sc1 lds
    v_exp_f32 v39, v39
    v_cvt_pk_bf16_f32 v24, v32, v33
    v_cvt_pk_bf16_f32 v25, v34, v35
    v_cvt_pk_bf16_f32 v26, v36, v37
    v_exp_f32 v40, v40
    v_cvt_pk_bf16_f32 v27, v38, v39
    v_mfma_f32_32x32x8_bf16 v[48:63], v[250:251], v[16:17], v[48:63]
    v_exp_f32 v41, v41
    v_exp_f32 v42, v42
    v_exp_f32 v43, v43
    v_exp_f32 v44, v44
    v_mfma_f32_32x32x16_bf16 v[64:79], v[208:211], v[24:27], v[64:79]
    buffer_load_dwordx4 v2, s[12:15], s75 offen offset:3072 sc1 lds
    v_exp_f32 v45, v45
    v_exp_f32 v46, v46
    v_exp_f32 v47, v47
    v_cvt_pk_bf16_f32 v28, v40, v41
    v_cvt_pk_bf16_f32 v29, v42, v43
    v_cvt_pk_bf16_f32 v30, v44, v45
    v_cvt_pk_bf16_f32 v31, v46, v47
    v_exp_f32 v48, v48
    v_exp_f32 v49, v49
    v_exp_f32 v50, v50
    v_mfma_f32_32x32x16_bf16 v[64:79], v[212:215], v[28:31], v[64:79]
    v_exp_f32 v51, v51
    v_exp_f32 v52, v52
    v_exp_f32 v53, v53
    v_exp_f32 v54, v54
    v_mfma_f32_32x32x16_bf16 v[32:47], v[168:171], v[12:15], 0
    s_add_u32 m0, m0, 4096
    s_add_u32 s65, s75, 4096
    buffer_load_dwordx4 v2, s[12:15], s65 offen offset:0 sc1 lds
    v_exp_f32 v55, v55
    v_cvt_pk_bf16_f32 v24, v48, v49
    v_cvt_pk_bf16_f32 v25, v50, v51
    v_cvt_pk_bf16_f32 v26, v52, v53
    v_exp_f32 v56, v56
    v_cvt_pk_bf16_f32 v27, v54, v55
    v_mfma_f32_32x32x8_bf16 v[32:47], v[252:253], v[16:17], v[32:47]
    s_add_u32 s64, s48, 6
    s_and_b32 s64, s64, 7
    v_mad_u32_u24 v7, v11, s64, v10
    s_mul_i32 s64, s64, 1280
    v_add_u32 v6, s64, v9
    v_exp_f32 v57, v57
    v_exp_f32 v58, v58
    v_exp_f32 v59, v59
    v_exp_f32 v60, v60
    v_mfma_f32_32x32x16_bf16 v[64:79], v[216:219], v[24:27], v[64:79]
    v_exp_f32 v61, v61
    v_exp_f32 v62, v62
    v_exp_f32 v63, v63
    v_cvt_pk_bf16_f32 v28, v56, v57
    v_cvt_pk_bf16_f32 v29, v58, v59
    v_cvt_pk_bf16_f32 v30, v60, v61
    v_cvt_pk_bf16_f32 v31, v62, v63
    v_exp_f32 v32, v32
    v_exp_f32 v33, v33
    v_exp_f32 v34, v34
    v_mfma_f32_32x32x16_bf16 v[64:79], v[220:223], v[28:31], v[64:79]
    s_cmp_ge_u32 s48, 4
    s_cselect_b64 vcc, -1, 0
    s_add_u32 s75, s75, 327680
    s_add_u32 m0, s58, 81920
    s_cbranch_vccnz L_gd_37
    buffer_load_dwordx4 v2, s[12:15], s75 offen offset:0 sc1 lds
L_gd_37:
    v_exp_f32 v35, v35
    v_exp_f32 v36, v36
    v_exp_f32 v37, v37
    v_exp_f32 v38, v38
    v_mfma_f32_32x32x16_bf16 v[48:63], v[172:175], v[12:15], 0
    s_cbranch_vccnz L_gd_38
    buffer_load_dwordx4 v2, s[12:15], s75 offen offset:1024 sc1 lds
L_gd_38:
    ds_read2_b64 v[12:15], v6 offset0:0 offset1:32
    v_exp_f32 v39, v39
    v_cvt_pk_bf16_f32 v24, v32, v33
    v_cvt_pk_bf16_f32 v25, v34, v35
    v_cvt_pk_bf16_f32 v26, v36, v37
    v_exp_f32 v40, v40
    v_cvt_pk_bf16_f32 v27, v38, v39
    v_mfma_f32_32x32x8_bf16 v[48:63], v[254:255], v[16:17], v[48:63]
    ds_read_b64 v[16:17], v7 offset:1024
    v_exp_f32 v41, v41
    v_exp_f32 v42, v42
    v_exp_f32 v43, v43
    v_exp_f32 v44, v44
    v_mfma_f32_32x32x16_bf16 v[64:79], v[224:227], v[24:27], v[64:79]
    v_exp_f32 v45, v45
    v_exp_f32 v46, v46
    v_exp_f32 v47, v47
    v_cvt_pk_bf16_f32 v28, v40, v41
    v_cvt_pk_bf16_f32 v29, v42, v43
    v_cvt_pk_bf16_f32 v30, v44, v45
    v_cvt_pk_bf16_f32 v31, v46, v47
    v_exp_f32 v48, v48
    v_exp_f32 v49, v49
    v_exp_f32 v50, v50
    v_mfma_f32_32x32x16_bf16 v[64:79], v[228:231], v[28:31], v[64:79]
    s_cbranch_vccnz L_gd_39
    buffer_load_dwordx4 v2, s[12:15], s75 offen offset:2048 sc1 lds
L_gd_39:
    v_exp_f32 v51, v51
    v_exp_f32 v52, v52
    v_exp_f32 v53, v53
    v_exp_f32 v54, v54
    s_waitcnt lgkmcnt(0)
    v_mfma_f32_32x32x16_bf16 v[32:47], v[144:147], v[12:15], 0
    v_exp_f32 v55, v55
    v_cvt_pk_bf16_f32 v24, v48, v49
    v_cvt_pk_bf16_f32 v25, v50, v51
    v_cvt_pk_bf16_f32 v26, v52, v53
    v_exp_f32 v56, v56
    v_cvt_pk_bf16_f32 v27, v54, v55
    v_mfma_f32_32x32x8_bf16 v[32:47], v[240:241], v[16:17], v[32:47]
    v_exp_f32 v57, v57
    v_exp_f32 v58, v58
    v_exp_f32 v59, v59
    v_exp_f32 v60, v60
    v_mfma_f32_32x32x16_bf16 v[64:79], v[232:235], v[24:27], v[64:79]
    v_exp_f32 v61, v61
    v_exp_f32 v62, v62
    v_exp_f32 v63, v63
    v_cvt_pk_bf16_f32 v28, v56, v57
    v_cvt_pk_bf16_f32 v29, v58, v59
    v_cvt_pk_bf16_f32 v30, v60, v61
    v_cvt_pk_bf16_f32 v31, v62, v63
    s_setprio 2
    v_exp_f32 v32, v32
    v_exp_f32 v33, v33
    v_exp_f32 v34, v34
    v_mfma_f32_32x32x16_bf16 v[64:79], v[236:239], v[28:31], v[64:79]
    s_cbranch_vccnz L_gd_40
    buffer_load_dwordx4 v2, s[12:15], s75 offen offset:3072 sc1 lds
L_gd_40:
    v_exp_f32 v35, v35
    v_exp_f32 v36, v36
    v_exp_f32 v37, v37
    v_exp_f32 v38, v38
    v_mfma_f32_32x32x16_bf16 v[48:63], v[148:151], v[12:15], 0
    v_exp_f32 v39, v39
    v_cvt_pk_bf16_f32 v24, v32, v33
    v_cvt_pk_bf16_f32 v25, v34, v35
    v_cvt_pk_bf16_f32 v26, v36, v37
    v_exp_f32 v40, v40
    v_cvt_pk_bf16_f32 v27, v38, v39
    v_mfma_f32_32x32x8_bf16 v[48:63], v[242:243], v[16:17], v[48:63]
    v_exp_f32 v41, v41
    v_exp_f32 v42, v42
    v_exp_f32 v43, v43
    v_exp_f32 v44, v44
    v_pk_add_f32 v[18:19], v[72:73], v[18:19]
    v_pk_add_f32 v[20:21], v[74:75], v[20:21]
    v_pk_add_f32 v[80:81], v[64:65], v[80:81]
    v_pk_add_f32 v[82:83], v[66:67], v[82:83]
    v_pk_add_f32 v[84:85], v[68:69], v[84:85]
    v_pk_add_f32 v[86:87], v[70:71], v[86:87]
    v_mfma_f32_32x32x16_bf16 v[64:79], v[176:179], v[24:27], 0
    s_cbranch_vccnz L_gd_41
    s_add_u32 m0, m0, 4096
    s_add_u32 s65, s75, 4096
    buffer_load_dwordx4 v2, s[12:15], s65 offen offset:0 sc1 lds
L_gd_41:
    ds_write_b128 v8, v[80:83]
    v_exp_f32 v45, v45
    v_exp_f32 v46, v46
    v_exp_f32 v47, v47
    v_cvt_pk_bf16_f32 v28, v40, v41
    v_cvt_pk_bf16_f32 v29, v42, v43
    v_cvt_pk_bf16_f32 v30, v44, v45
    v_cvt_pk_bf16_f32 v31, v46, v47
    s_setprio 1
    v_exp_f32 v48, v48
    v_exp_f32 v49, v49
    v_exp_f32 v50, v50
    v_mfma_f32_32x32x16_bf16 v[64:79], v[180:183], v[28:31], v[64:79]
    ds_write_b128 v8, v[84:87] offset:1024
    v_exp_f32 v51, v51
    v_exp_f32 v52, v52
    v_exp_f32 v53, v53
    v_exp_f32 v54, v54
    v_mfma_f32_32x32x16_bf16 v[32:47], v[152:155], v[12:15], 0
    buffer_load_dwordx4 v[88:91], v2, s[12:15], s73 offen offset:0 sc1
    ds_write_b128 v8, v[18:21] offset:2048
    v_exp_f32 v55, v55
    v_cvt_pk_bf16_f32 v24, v48, v49
    v_cvt_pk_bf16_f32 v25, v50, v51
    v_cvt_pk_bf16_f32 v26, v52, v53
    v_exp_f32 v56, v56
    v_cvt_pk_bf16_f32 v27, v54, v55
    v_mfma_f32_32x32x8_bf16 v[32:47], v[244:245], v[16:17], v[32:47]
    v_exp_f32 v57, v57
    v_exp_f32 v58, v58
    v_exp_f32 v59, v59
    v_exp_f32 v60, v60
    v_mfma_f32_32x32x16_bf16 v[64:79], v[184:187], v[24:27], v[64:79]
    v_exp_f32 v61, v61
    v_exp_f32 v62, v62
    v_exp_f32 v63, v63
    v_cvt_pk_bf16_f32 v28, v56, v57
    v_cvt_pk_bf16_f32 v29, v58, v59
    v_cvt_pk_bf16_f32 v30, v60, v61
    v_cvt_pk_bf16_f32 v31, v62, v63
    s_setprio 0
    v_exp_f32 v32, v32
    v_exp_f32 v33, v33
    v_exp_f32 v34, v34
    v_mfma_f32_32x32x16_bf16 v[64:79], v[188:191], v[28:31], v[64:79]
    buffer_load_dwordx4 v[92:95], v2, s[12:15], s74 offen offset:0 sc1
    v_exp_f32 v35, v35
    v_exp_f32 v36, v36
    v_exp_f32 v37, v37
    v_exp_f32 v38, v38
    v_mfma_f32_32x32x16_bf16 v[48:63], v[156:159], v[12:15], 0
    v_exp_f32 v39, v39
    v_cvt_pk_bf16_f32 v24, v32, v33
    v_cvt_pk_bf16_f32 v25, v34, v35
    v_cvt_pk_bf16_f32 v26, v36, v37
    v_exp_f32 v40, v40
    v_cvt_pk_bf16_f32 v27, v38, v39
    v_mfma_f32_32x32x8_bf16 v[48:63], v[246:247], v[16:17], v[48:63]
    v_exp_f32 v41, v41
    v_exp_f32 v42, v42
    v_exp_f32 v43, v43
    v_exp_f32 v44, v44
    v_mfma_f32_32x32x16_bf16 v[64:79], v[192:195], v[24:27], v[64:79]
    v_exp_f32 v45, v45
    v_exp_f32 v46, v46
    v_exp_f32 v47, v47
    v_cvt_pk_bf16_f32 v28, v40, v41
    v_cvt_pk_bf16_f32 v29, v42, v43
    v_cvt_pk_bf16_f32 v30, v44, v45
    v_cvt_pk_bf16_f32 v31, v46, v47
    s_setprio 3
    s_waitcnt lgkmcnt(0)
    s_barrier
    s_add_u32 s64, s48, 6
    s_and_b32 s64, s64, 7
    s_mul_i32 s64, s64, 3072
    s_add_u32 s64, s64, 114688
    v_add_u32 v8, s64, v2
    v_exp_f32 v48, v48
    v_exp_f32 v49, v49
    v_exp_f32 v50, v50
    v_mfma_f32_32x32x16_bf16 v[64:79], v[196:199], v[28:31], v[64:79]
    ds_read_b128 v[80:83], v8
    v_exp_f32 v51, v51
    v_exp_f32 v52, v52
    v_exp_f32 v53, v53
    v_exp_f32 v54, v54
    v_mfma_f32_32x32x16_bf16 v[32:47], v[160:163], v[12:15], 0
    buffer_load_dwordx4 v[96:99], v2, s[12:15], s21 offen offset:0 sc1
    ds_read_b128 v[84:87], v8 offset:1024
    v_exp_f32 v55, v55
    v_cvt_pk_bf16_f32 v24, v48, v49
    v_cvt_pk_bf16_f32 v25, v50, v51
    v_cvt_pk_bf16_f32 v26, v52, v53
    v_exp_f32 v56, v56
    v_cvt_pk_bf16_f32 v27, v54, v55
    v_mfma_f32_32x32x8_bf16 v[32:47], v[248:249], v[16:17], v[32:47]
    ds_read_b128 v[18:21], v8 offset:2048
    v_exp_f32 v57, v57
    v_exp_f32 v58, v58
    v_exp_f32 v59, v59
    v_exp_f32 v60, v60
    v_mfma_f32_32x32x16_bf16 v[64:79], v[200:203], v[24:27], v[64:79]
    v_exp_f32 v61, v61
    v_exp_f32 v62, v62
    v_exp_f32 v63, v63
    v_cvt_pk_bf16_f32 v28, v56, v57
    v_cvt_pk_bf16_f32 v29, v58, v59
    v_cvt_pk_bf16_f32 v30, v60, v61
    v_cvt_pk_bf16_f32 v31, v62, v63
    v_exp_f32 v32, v32
    v_exp_f32 v33, v33
    v_exp_f32 v34, v34
    v_mfma_f32_32x32x16_bf16 v[64:79], v[204:207], v[28:31], v[64:79]
    s_add_u32 s65, s73, 4096
    buffer_load_dwordx4 v[100:103], v2, s[12:15], s65 offen offset:0 sc1
    v_exp_f32 v35, v35
    v_exp_f32 v36, v36
    v_exp_f32 v37, v37
    v_exp_f32 v38, v38
    v_mfma_f32_32x32x16_bf16 v[48:63], v[164:167], v[12:15], 0
    v_exp_f32 v39, v39
    v_cvt_pk_bf16_f32 v24, v32, v33
    v_cvt_pk_bf16_f32 v25, v34, v35
    v_cvt_pk_bf16_f32 v26, v36, v37
    v_exp_f32 v40, v40
    v_cvt_pk_bf16_f32 v27, v38, v39
    v_mfma_f32_32x32x8_bf16 v[48:63], v[250:251], v[16:17], v[48:63]
    v_exp_f32 v41, v41
    v_exp_f32 v42, v42
    v_exp_f32 v43, v43
    v_exp_f32 v44, v44
    v_mfma_f32_32x32x16_bf16 v[64:79], v[208:211], v[24:27], v[64:79]
    s_add_u32 s65, s74, 4096
    buffer_load_dwordx4 v[104:107], v2, s[12:15], s65 offen offset:0 sc1
    v_exp_f32 v45, v45
    v_exp_f32 v46, v46
    v_exp_f32 v47, v47
    v_cvt_pk_bf16_f32 v28, v40, v41
    v_cvt_pk_bf16_f32 v29, v42, v43
    v_cvt_pk_bf16_f32 v30, v44, v45
    v_cvt_pk_bf16_f32 v31, v46, v47
    v_exp_f32 v48, v48
    v_exp_f32 v49, v49
    v_exp_f32 v50, v50
    v_mfma_f32_32x32x16_bf16 v[64:79], v[212:215], v[28:31], v[64:79]
    v_exp_f32 v51, v51
    v_exp_f32 v52, v52
    v_exp_f32 v53, v53
    v_exp_f32 v54, v54
    v_mfma_f32_32x32x16_bf16 v[32:47], v[168:171], v[12:15], 0
    s_add_u32 s65, s21, 4096
    buffer_load_dwordx4 v[108:111], v2, s[12:15], s65 offen offset:0 sc1
    v_exp_f32 v55, v55
    v_cvt_pk_bf16_f32 v24, v48, v49
    v_cvt_pk_bf16_f32 v25, v50, v51
    v_cvt_pk_bf16_f32 v26, v52, v53
    v_exp_f32 v56, v56
    v_cvt_pk_bf16_f32 v27, v54, v55
    v_mfma_f32_32x32x8_bf16 v[32:47], v[252:253], v[16:17], v[32:47]
    s_add_u32 s64, s48, 7
    s_and_b32 s64, s64, 7
    v_mad_u32_u24 v7, v11, s64, v10
    s_mul_i32 s64, s64, 1280
    v_add_u32 v6, s64, v9
    v_exp_f32 v57, v57
    v_exp_f32 v58, v58
    v_exp_f32 v59, v59
    v_exp_f32 v60, v60
    v_mfma_f32_32x32x16_bf16 v[64:79], v[216:219], v[24:27], v[64:79]
    v_exp_f32 v61, v61
    v_exp_f32 v62, v62
    v_exp_f32 v63, v63
    v_cvt_pk_bf16_f32 v28, v56, v57
    v_cvt_pk_bf16_f32 v29, v58, v59
    v_cvt_pk_bf16_f32 v30, v60, v61
    v_cvt_pk_bf16_f32 v31, v62, v63
    v_exp_f32 v32, v32
    v_exp_f32 v33, v33
    v_exp_f32 v34, v34
    v_mfma_f32_32x32x16_bf16 v[64:79], v[220:223], v[28:31], v[64:79]
    v_and_b32 v142, 7, v1
    v_lshlrev_b32 v142, 3, v142
    s_lshl_b32 s65, s51, 6
    s_add_u32 s65, s65, 16384
    buffer_load_dwordx2 v[140:141], v142, s[12:15], s65 offen sc1
    v_exp_f32 v35, v35
    v_exp_f32 v36, v36
    v_exp_f32 v37, v37
    v_exp_f32 v38, v38
    v_mfma_f32_32x32x16_bf16 v[48:63], v[172:175], v[12:15], 0
    ds_read2_b64 v[12:15], v6 offset0:0 offset1:32
    v_exp_f32 v39, v39
    v_cvt_pk_bf16_f32 v24, v32, v33
    v_cvt_pk_bf16_f32 v25, v34, v35
    v_cvt_pk_bf16_f32 v26, v36, v37
    v_exp_f32 v40, v40
    v_cvt_pk_bf16_f32 v27, v38, v39
    v_mfma_f32_32x32x8_bf16 v[48:63], v[254:255], v[16:17], v[48:63]
    ds_read_b64 v[16:17], v7 offset:1024
    v_exp_f32 v41, v41
    v_exp_f32 v42, v42
    v_exp_f32 v43, v43
    v_exp_f32 v44, v44
    v_mfma_f32_32x32x16_bf16 v[64:79], v[224:227], v[24:27], v[64:79]
    s_add_u32 s65, s73, 8192
    buffer_load_dwordx4 v[112:115], v2, s[12:15], s65 offen offset:0 sc1
    v_exp_f32 v45, v45
    v_exp_f32 v46, v46
    v_exp_f32 v47, v47
    v_cvt_pk_bf16_f32 v28, v40, v41
    v_cvt_pk_bf16_f32 v29, v42, v43
    v_cvt_pk_bf16_f32 v30, v44, v45
    v_cvt_pk_bf16_f32 v31, v46, v47
    v_exp_f32 v48, v48
    v_exp_f32 v49, v49
    v_exp_f32 v50, v50
    v_mfma_f32_32x32x16_bf16 v[64:79], v[228:231], v[28:31], v[64:79]
    v_exp_f32 v51, v51
    v_exp_f32 v52, v52
    v_exp_f32 v53, v53
    v_exp_f32 v54, v54
    s_waitcnt lgkmcnt(0)
    v_mfma_f32_32x32x16_bf16 v[32:47], v[144:147], v[12:15], 0
    v_exp_f32 v55, v55
    v_cvt_pk_bf16_f32 v24, v48, v49
    v_cvt_pk_bf16_f32 v25, v50, v51
    v_cvt_pk_bf16_f32 v26, v52, v53
    v_exp_f32 v56, v56
    v_cvt_pk_bf16_f32 v27, v54, v55
    v_mfma_f32_32x32x8_bf16 v[32:47], v[240:241], v[16:17], v[32:47]
    v_exp_f32 v57, v57
    v_exp_f32 v58, v58
    v_exp_f32 v59, v59
    v_exp_f32 v60, v60
    v_mfma_f32_32x32x16_bf16 v[64:79], v[232:235], v[24:27], v[64:79]
    v_exp_f32 v61, v61
    v_exp_f32 v62, v62
    v_exp_f32 v63, v63
    v_cvt_pk_bf16_f32 v28, v56, v57
    v_cvt_pk_bf16_f32 v29, v58, v59
    v_cvt_pk_bf16_f32 v30, v60, v61
    v_cvt_pk_bf16_f32 v31, v62, v63
    s_setprio 2
    v_exp_f32 v32, v32
    v_exp_f32 v33, v33
    v_exp_f32 v34, v34
    v_mfma_f32_32x32x16_bf16 v[64:79], v[236:239], v[28:31], v[64:79]
    s_add_u32 s65, s74, 8192
    buffer_load_dwordx4 v[116:119], v2, s[12:15], s65 offen offset:0 sc1
    v_exp_f32 v35, v35
    v_exp_f32 v36, v36
    v_exp_f32 v37, v37
    v_exp_f32 v38, v38
    v_mfma_f32_32x32x16_bf16 v[48:63], v[148:151], v[12:15], 0
    v_exp_f32 v39, v39
    v_cvt_pk_bf16_f32 v24, v32, v33
    v_cvt_pk_bf16_f32 v25, v34, v35
    v_cvt_pk_bf16_f32 v26, v36, v37
    v_exp_f32 v40, v40
    v_cvt_pk_bf16_f32 v27, v38, v39
    v_mfma_f32_32x32x8_bf16 v[48:63], v[242:243], v[16:17], v[48:63]
    v_exp_f32 v41, v41
    v_exp_f32 v42, v42
    v_exp_f32 v43, v43
    v_exp_f32 v44, v44
    v_pk_add_f32 v[18:19], v[72:73], v[18:19]
    v_pk_add_f32 v[20:21], v[74:75], v[20:21]
    v_pk_add_f32 v[80:81], v[64:65], v[80:81]
    v_pk_add_f32 v[82:83], v[66:67], v[82:83]
    v_pk_add_f32 v[84:85], v[68:69], v[84:85]
    v_pk_add_f32 v[86:87], v[70:71], v[86:87]
    v_mfma_f32_32x32x16_bf16 v[64:79], v[176:179], v[24:27], 0
    ds_write_b128 v8, v[80:83]
    v_exp_f32 v45, v45
    v_exp_f32 v46, v46
    v_exp_f32 v47, v47
    v_cvt_pk_bf16_f32 v28, v40, v41
    v_cvt_pk_bf16_f32 v29, v42, v43
    v_cvt_pk_bf16_f32 v30, v44, v45
    v_cvt_pk_bf16_f32 v31, v46, v47
    s_setprio 1
    v_exp_f32 v48, v48
    v_exp_f32 v49, v49
    v_exp_f32 v50, v50
    v_mfma_f32_32x32x16_bf16 v[64:79], v[180:183], v[28:31], v[64:79]
    s_add_u32 s65, s21, 8192
    buffer_load_dwordx4 v[120:123], v2, s[12:15], s65 offen offset:0 sc1
    ds_write_b128 v8, v[84:87] offset:1024
    v_exp_f32 v51, v51
    v_exp_f32 v52, v52
    v_exp_f32 v53, v53
    v_exp_f32 v54, v54
    v_mfma_f32_32x32x16_bf16 v[32:47], v[152:155], v[12:15], 0
    ds_write_b128 v8, v[18:21] offset:2048
    v_exp_f32 v55, v55
    v_cvt_pk_bf16_f32 v24, v48, v49
    v_cvt_pk_bf16_f32 v25, v50, v51
    v_cvt_pk_bf16_f32 v26, v52, v53
    v_exp_f32 v56, v56
    v_cvt_pk_bf16_f32 v27, v54, v55
    v_mfma_f32_32x32x8_bf16 v[32:47], v[244:245], v[16:17], v[32:47]
    v_exp_f32 v57, v57
    v_exp_f32 v58, v58
    v_exp_f32 v59, v59
    v_exp_f32 v60, v60
    v_mfma_f32_32x32x16_bf16 v[64:79], v[184:187], v[24:27], v[64:79]
    v_exp_f32 v61, v61
    v_exp_f32 v62, v62
    v_exp_f32 v63, v63
    v_cvt_pk_bf16_f32 v28, v56, v57
    v_cvt_pk_bf16_f32 v29, v58, v59
    v_cvt_pk_bf16_f32 v30, v60, v61
    v_cvt_pk_bf16_f32 v31, v62, v63
    s_setprio 0
    v_exp_f32 v32, v32
    v_exp_f32 v33, v33
    v_exp_f32 v34, v34
    v_mfma_f32_32x32x16_bf16 v[64:79], v[188:191], v[28:31], v[64:79]
    s_add_u32 s65, s73, 12288
    buffer_load_dwordx4 v[124:127], v2, s[12:15], s65 offen offset:0 sc1
    v_exp_f32 v35, v35
    v_exp_f32 v36, v36
    v_exp_f32 v37, v37
    v_exp_f32 v38, v38
    v_mfma_f32_32x32x16_bf16 v[48:63], v[156:159], v[12:15], 0
    v_exp_f32 v39, v39
    v_cvt_pk_bf16_f32 v24, v32, v33
    v_cvt_pk_bf16_f32 v25, v34, v35
    v_cvt_pk_bf16_f32 v26, v36, v37
    v_exp_f32 v40, v40
    v_cvt_pk_bf16_f32 v27, v38, v39
    v_mfma_f32_32x32x8_bf16 v[48:63], v[246:247], v[16:17], v[48:63]
    v_exp_f32 v41, v41
    v_exp_f32 v42, v42
    v_exp_f32 v43, v43
    v_exp_f32 v44, v44
    v_mfma_f32_32x32x16_bf16 v[64:79], v[192:195], v[24:27], v[64:79]
    v_exp_f32 v45, v45
    v_exp_f32 v46, v46
    v_exp_f32 v47, v47
    v_cvt_pk_bf16_f32 v28, v40, v41
    v_cvt_pk_bf16_f32 v29, v42, v43
    v_cvt_pk_bf16_f32 v30, v44, v45
    v_cvt_pk_bf16_f32 v31, v46, v47
    s_setprio 3
    s_waitcnt lgkmcnt(0)
    s_barrier
    s_add_u32 s64, s48, 7
    s_and_b32 s64, s64, 7
    s_mul_i32 s64, s64, 3072
    s_add_u32 s64, s64, 114688
    v_add_u32 v8, s64, v2
    v_exp_f32 v48, v48
    v_exp_f32 v49, v49
    v_exp_f32 v50, v50
    v_mfma_f32_32x32x16_bf16 v[64:79], v[196:199], v[28:31], v[64:79]
    ds_read_b128 v[80:83], v8
    v_exp_f32 v51, v51
    v_exp_f32 v52, v52
    v_exp_f32 v53, v53
    v_exp_f32 v54, v54
    v_mfma_f32_32x32x16_bf16 v[32:47], v[160:163], v[12:15], 0
    s_add_u32 s65, s74, 12288
    buffer_load_dwordx4 v[128:131], v2, s[12:15], s65 offen offset:0 sc1
    ds_read_b128 v[84:87], v8 offset:1024
    v_exp_f32 v55, v55
    v_cvt_pk_bf16_f32 v24, v48, v49
    v_cvt_pk_bf16_f32 v25, v50, v51
    v_cvt_pk_bf16_f32 v26, v52, v53
    v_exp_f32 v56, v56
    v_cvt_pk_bf16_f32 v27, v54, v55
    v_mfma_f32_32x32x8_bf16 v[32:47], v[248:249], v[16:17], v[32:47]
    ds_read_b128 v[18:21], v8 offset:2048
    v_exp_f32 v57, v57
    v_exp_f32 v58, v58
    v_exp_f32 v59, v59
    v_exp_f32 v60, v60
    v_mfma_f32_32x32x16_bf16 v[64:79], v[200:203], v[24:27], v[64:79]
    v_exp_f32 v61, v61
    v_exp_f32 v62, v62
    v_exp_f32 v63, v63
    v_cvt_pk_bf16_f32 v28, v56, v57
    v_cvt_pk_bf16_f32 v29, v58, v59
    v_cvt_pk_bf16_f32 v30, v60, v61
    v_cvt_pk_bf16_f32 v31, v62, v63
    v_exp_f32 v32, v32
    v_exp_f32 v33, v33
    v_exp_f32 v34, v34
    v_mfma_f32_32x32x16_bf16 v[64:79], v[204:207], v[28:31], v[64:79]
    s_waitcnt vmcnt(5)
    v_cmp_ne_u32 vcc, s54, v140
    s_getreg_b32 s64, hwreg(HW_REG_XCC_ID)
    s_cbranch_vccnz L_gp
L_gp_r:
    v_cmp_ne_u32 vcc, s64, v141
    s_nop 0
    s_cmp_eq_u64 vcc, 0
    s_cselect_b32 s63, 1, 0
    v_exp_f32 v35, v35
    v_exp_f32 v36, v36
    v_exp_f32 v37, v37
    v_exp_f32 v38, v38
    v_mfma_f32_32x32x16_bf16 v[48:63], v[164:167], v[12:15], 0
    v_exp_f32 v39, v39
    v_cvt_pk_bf16_f32 v24, v32, v33
    v_cvt_pk_bf16_f32 v25, v34, v35
    v_cvt_pk_bf16_f32 v26, v36, v37
    v_exp_f32 v40, v40
    v_cvt_pk_bf16_f32 v27, v38, v39
    v_mfma_f32_32x32x8_bf16 v[48:63], v[250:251], v[16:17], v[48:63]
    v_exp_f32 v41, v41
    v_exp_f32 v42, v42
    v_exp_f32 v43, v43
    v_exp_f32 v44, v44
    v_mfma_f32_32x32x16_bf16 v[64:79], v[208:211], v[24:27], v[64:79]
    s_add_u32 s65, s21, 12288
    buffer_load_dwordx4 v[132:135], v2, s[12:15], s65 offen offset:0 sc1
    v_exp_f32 v45, v45
    v_exp_f32 v46, v46
    v_exp_f32 v47, v47
    v_cvt_pk_bf16_f32 v28, v40, v41
    v_cvt_pk_bf16_f32 v29, v42, v43
    v_cvt_pk_bf16_f32 v30, v44, v45
    v_cvt_pk_bf16_f32 v31, v46, v47
    v_exp_f32 v48, v48
    v_exp_f32 v49, v49
    v_exp_f32 v50, v50
    v_mfma_f32_32x32x16_bf16 v[64:79], v[212:215], v[28:31], v[64:79]
    v_exp_f32 v51, v51
    v_exp_f32 v52, v52
    v_exp_f32 v53, v53
    v_exp_f32 v54, v54
    v_mfma_f32_32x32x16_bf16 v[32:47], v[168:171], v[12:15], 0
    s_add_u32 s65, s73, 16384
    buffer_load_dwordx4 v[136:139], v2, s[12:15], s65 offen offset:0 sc1
    v_exp_f32 v55, v55
    v_cvt_pk_bf16_f32 v24, v48, v49
    v_cvt_pk_bf16_f32 v25, v50, v51
    v_cvt_pk_bf16_f32 v26, v52, v53
    v_exp_f32 v56, v56
    v_cvt_pk_bf16_f32 v27, v54, v55
    v_mfma_f32_32x32x8_bf16 v[32:47], v[252:253], v[16:17], v[32:47]
    s_add_u32 s64, s48, 8
    s_and_b32 s64, s64, 7
    v_mad_u32_u24 v7, v11, s64, v10
    s_mul_i32 s64, s64, 1280
    v_add_u32 v6, s64, v9
    v_exp_f32 v57, v57
    v_exp_f32 v58, v58
    v_exp_f32 v59, v59
    v_exp_f32 v60, v60
    v_mfma_f32_32x32x16_bf16 v[64:79], v[216:219], v[24:27], v[64:79]
    v_exp_f32 v61, v61
    v_exp_f32 v62, v62
    v_exp_f32 v63, v63
    v_cvt_pk_bf16_f32 v28, v56, v57
    v_cvt_pk_bf16_f32 v29, v58, v59
    v_cvt_pk_bf16_f32 v30, v60, v61
    v_cvt_pk_bf16_f32 v31, v62, v63
    v_exp_f32 v32, v32
    v_exp_f32 v33, v33
    v_exp_f32 v34, v34
    v_mfma_f32_32x32x16_bf16 v[64:79], v[220:223], v[28:31], v[64:79]
    s_add_u32 s65, s74, 16384
    buffer_load_dwordx4 v[140:143], v2, s[12:15], s65 offen offset:0 sc1
    v_exp_f32 v35, v35
    v_exp_f32 v36, v36
    v_exp_f32 v37, v37
    v_exp_f32 v38, v38
    v_mfma_f32_32x32x16_bf16 v[48:63], v[172:175], v[12:15], 0
    ds_read2_b64 v[12:15], v6 offset0:0 offset1:32
    v_exp_f32 v39, v39
    v_cvt_pk_bf16_f32 v24, v32, v33
    v_cvt_pk_bf16_f32 v25, v34, v35
    v_cvt_pk_bf16_f32 v26, v36, v37
    v_exp_f32 v40, v40
    v_cvt_pk_bf16_f32 v27, v38, v39
    v_mfma_f32_32x32x8_bf16 v[48:63], v[254:255], v[16:17], v[48:63]
    ds_read_b64 v[16:17], v7 offset:1024
    v_exp_f32 v41, v41
    v_exp_f32 v42, v42
    v_exp_f32 v43, v43
    v_exp_f32 v44, v44
    v_mfma_f32_32x32x16_bf16 v[64:79], v[224:227], v[24:27], v[64:79]
    v_exp_f32 v45, v45
    v_exp_f32 v46, v46
    v_exp_f32 v47, v47
    v_cvt_pk_bf16_f32 v28, v40, v41
    v_cvt_pk_bf16_f32 v29, v42, v43
    v_cvt_pk_bf16_f32 v30, v44, v45
    v_cvt_pk_bf16_f32 v31, v46, v47
    v_exp_f32 v48, v48
    v_exp_f32 v49, v49
    v_exp_f32 v50, v50
    v_mfma_f32_32x32x16_bf16 v[64:79], v[228:231], v[28:31], v[64:79]
    v_exp_f32 v51, v51
    v_exp_f32 v52, v52
    v_exp_f32 v53, v53
    v_exp_f32 v54, v54
    s_waitcnt lgkmcnt(0)
    v_mfma_f32_32x32x16_bf16 v[32:47], v[144:147], v[12:15], 0
    v_exp_f32 v55, v55
    v_cvt_pk_bf16_f32 v24, v48, v49
    v_cvt_pk_bf16_f32 v25, v50, v51
    v_cvt_pk_bf16_f32 v26, v52, v53
    v_exp_f32 v56, v56
    v_cvt_pk_bf16_f32 v27, v54, v55
    v_mfma_f32_32x32x8_bf16 v[32:47], v[240:241], v[16:17], v[32:47]
    v_exp_f32 v57, v57
    v_exp_f32 v58, v58
    v_exp_f32 v59, v59
    v_exp_f32 v60, v60
    v_mfma_f32_32x32x16_bf16 v[64:79], v[232:235], v[24:27], v[64:79]
    v_exp_f32 v61, v61
    v_exp_f32 v62, v62
    v_exp_f32 v63, v63
    v_cvt_pk_bf16_f32 v28, v56, v57
    v_cvt_pk_bf16_f32 v29, v58, v59
    v_cvt_pk_bf16_f32 v30, v60, v61
    v_cvt_pk_bf16_f32 v31, v62, v63
    s_setprio 2
    v_exp_f32 v32, v32
    v_exp_f32 v33, v33
    v_exp_f32 v34, v34
    v_mfma_f32_32x32x16_bf16 v[64:79], v[236:239], v[28:31], v[64:79]
    s_add_u32 s65, s21, 16384
    buffer_load_dwordx4 v[144:147], v2, s[12:15], s65 offen offset:0 sc1
    v_exp_f32 v35, v35
    v_exp_f32 v36, v36
    v_exp_f32 v37, v37
    v_exp_f32 v38, v38
    v_mfma_f32_32x32x16_bf16 v[48:63], v[148:151], v[12:15], 0
    s_add_u32 s65, s73, 20480
    buffer_load_dwordx4 v[148:151], v2, s[12:15], s65 offen offset:0 sc1
    v_exp_f32 v39, v39
    v_cvt_pk_bf16_f32 v24, v32, v33
    v_cvt_pk_bf16_f32 v25, v34, v35
    v_cvt_pk_bf16_f32 v26, v36, v37
    v_exp_f32 v40, v40
    v_cvt_pk_bf16_f32 v27, v38, v39
    v_mfma_f32_32x32x8_bf16 v[48:63], v[242:243], v[16:17], v[48:63]
    v_exp_f32 v41, v41
    v_exp_f32 v42, v42
    v_exp_f32 v43, v43
    v_exp_f32 v44, v44
    v_pk_add_f32 v[18:19], v[72:73], v[18:19]
    v_pk_add_f32 v[20:21], v[74:75], v[20:21]
    v_pk_add_f32 v[80:81], v[64:65], v[80:81]
    v_pk_add_f32 v[82:83], v[66:67], v[82:83]
    v_pk_add_f32 v[84:85], v[68:69], v[84:85]
    v_pk_add_f32 v[86:87], v[70:71], v[86:87]
    v_mfma_f32_32x32x16_bf16 v[64:79], v[176:179], v[24:27], 0
    ds_write_b128 v8, v[80:83]
    v_exp_f32 v45, v45
    v_exp_f32 v46, v46
    v_exp_f32 v47, v47
    v_cvt_pk_bf16_f32 v28, v40, v41
    v_cvt_pk_bf16_f32 v29, v42, v43
    v_cvt_pk_bf16_f32 v30, v44, v45
    v_cvt_pk_bf16_f32 v31, v46, v47
    s_setprio 1
    v_exp_f32 v48, v48
    v_exp_f32 v49, v49
    v_exp_f32 v50, v50
    v_mfma_f32_32x32x16_bf16 v[64:79], v[180:183], v[28:31], v[64:79]
    s_add_u32 s65, s74, 28672
    buffer_load_dwordx4 v[176:179], v2, s[12:15], s65 offen offset:0 sc1
    ds_write_b128 v8, v[84:87] offset:1024
    v_exp_f32 v51, v51
    v_exp_f32 v52, v52
    v_exp_f32 v53, v53
    v_exp_f32 v54, v54
    v_mfma_f32_32x32x16_bf16 v[32:47], v[152:155], v[12:15], 0
    s_add_u32 s65, s74, 20480
    buffer_load_dwordx4 v[152:155], v2, s[12:15], s65 offen offset:0 sc1
    ds_write_b128 v8, v[18:21] offset:2048
    v_exp_f32 v55, v55
    v_cvt_pk_bf16_f32 v24, v48, v49
    v_cvt_pk_bf16_f32 v25, v50, v51
    v_cvt_pk_bf16_f32 v26, v52, v53
    v_exp_f32 v56, v56
    v_cvt_pk_bf16_f32 v27, v54, v55
    v_mfma_f32_32x32x8_bf16 v[32:47], v[244:245], v[16:17], v[32:47]
    v_exp_f32 v57, v57
    v_exp_f32 v58, v58
    v_exp_f32 v59, v59
    v_exp_f32 v60, v60
    v_mfma_f32_32x32x16_bf16 v[64:79], v[184:187], v[24:27], v[64:79]
    s_add_u32 s65, s21, 28672
    buffer_load_dwordx4 v[180:183], v2, s[12:15], s65 offen offset:0 sc1
    v_exp_f32 v61, v61
    v_exp_f32 v62, v62
    v_exp_f32 v63, v63
    v_cvt_pk_bf16_f32 v28, v56, v57
    v_cvt_pk_bf16_f32 v29, v58, v59
    v_cvt_pk_bf16_f32 v30, v60, v61
    v_cvt_pk_bf16_f32 v31, v62, v63
    s_setprio 0
    v_exp_f32 v32, v32
    v_exp_f32 v33, v33
    v_exp_f32 v34, v34
    v_mfma_f32_32x32x16_bf16 v[64:79], v[188:191], v[28:31], v[64:79]
    v_exp_f32 v35, v35
    v_exp_f32 v36, v36
    v_exp_f32 v37, v37
    v_exp_f32 v38, v38
    v_mfma_f32_32x32x16_bf16 v[48:63], v[156:159], v[12:15], 0
    s_add_u32 s65, s21, 20480
    buffer_load_dwordx4 v[156:159], v2, s[12:15], s65 offen offset:0 sc1
    s_add_u32 s65, s73, 32768
    buffer_load_dwordx4 v[184:187], v2, s[12:15], s65 offen offset:0 sc1
    v_exp_f32 v39, v39
    v_cvt_pk_bf16_f32 v24, v32, v33
    v_cvt_pk_bf16_f32 v25, v34, v35
    v_cvt_pk_bf16_f32 v26, v36, v37
    v_exp_f32 v40, v40
    v_cvt_pk_bf16_f32 v27, v38, v39
    v_mfma_f32_32x32x8_bf16 v[48:63], v[246:247], v[16:17], v[48:63]
    v_exp_f32 v41, v41
    v_exp_f32 v42, v42
    v_exp_f32 v43, v43
    v_exp_f32 v44, v44
    v_mfma_f32_32x32x16_bf16 v[64:79], v[192:195], v[24:27], v[64:79]
    v_exp_f32 v45, v45
    v_exp_f32 v46, v46
    v_exp_f32 v47, v47
    v_cvt_pk_bf16_f32 v28, v40, v41
    v_cvt_pk_bf16_f32 v29, v42, v43
    v_cvt_pk_bf16_f32 v30, v44, v45
    v_cvt_pk_bf16_f32 v31, v46, v47
    s_setprio 2
    s_waitcnt lgkmcnt(0)
    s_barrier
    s_add_u32 s64, s48, 8
    s_and_b32 s64, s64, 7
    s_mul_i32 s64, s64, 3072
    s_add_u32 s64, s64, 114688
    v_add_u32 v8, s64, v2
    v_exp_f32 v48, v48
    v_exp_f32 v49, v49
    v_exp_f32 v50, v50
    v_mfma_f32_32x32x16_bf16 v[64:79], v[196:199], v[28:31], v[64:79]
    s_add_u32 s65, s74, 32768
    buffer_load_dwordx4 v[188:191], v2, s[12:15], s65 offen offset:0 sc1
    ds_read_b128 v[80:83], v8
    v_exp_f32 v51, v51
    v_exp_f32 v52, v52
    v_exp_f32 v53, v53
    v_exp_f32 v54, v54
    v_mfma_f32_32x32x16_bf16 v[32:47], v[160:163], v[12:15], 0
    s_add_u32 s65, s73, 24576
    buffer_load_dwordx4 v[160:163], v2, s[12:15], s65 offen offset:0 sc1
    ds_read_b128 v[84:87], v8 offset:1024
    v_exp_f32 v55, v55
    v_cvt_pk_bf16_f32 v24, v48, v49
    v_cvt_pk_bf16_f32 v25, v50, v51
    v_cvt_pk_bf16_f32 v26, v52, v53
    v_exp_f32 v56, v56
    v_cvt_pk_bf16_f32 v27, v54, v55
    v_mfma_f32_32x32x8_bf16 v[32:47], v[248:249], v[16:17], v[32:47]
    ds_read_b128 v[18:21], v8 offset:2048
    v_exp_f32 v57, v57
    v_exp_f32 v58, v58
    v_exp_f32 v59, v59
    v_exp_f32 v60, v60
    v_mfma_f32_32x32x16_bf16 v[64:79], v[200:203], v[24:27], v[64:79]
    s_add_u32 s65, s21, 32768
    buffer_load_dwordx4 v[192:195], v2, s[12:15], s65 offen offset:0 sc1
    v_exp_f32 v61, v61
    v_exp_f32 v62, v62
    v_exp_f32 v63, v63
    v_cvt_pk_bf16_f32 v28, v56, v57
    v_cvt_pk_bf16_f32 v29, v58, v59
    v_cvt_pk_bf16_f32 v30, v60, v61
    v_cvt_pk_bf16_f32 v31, v62, v63
    v_exp_f32 v32, v32
    v_exp_f32 v33, v33
    v_exp_f32 v34, v34
    v_mfma_f32_32x32x16_bf16 v[64:79], v[204:207], v[28:31], v[64:79]
    v_exp_f32 v35, v35
    v_exp_f32 v36, v36
    v_exp_f32 v37, v37
    v_exp_f32 v38, v38
    v_mfma_f32_32x32x16_bf16 v[48:63], v[164:167], v[12:15], 0
    s_add_u32 s65, s74, 24576
    buffer_load_dwordx4 v[164:167], v2, s[12:15], s65 offen offset:0 sc1
    s_add_u32 s65, s73, 36864
    buffer_load_dwordx4 v[196:199], v2, s[12:15], s65 offen offset:0 sc1
    v_exp_f32 v39, v39
    v_cvt_pk_bf16_f32 v24, v32, v33
    v_cvt_pk_bf16_f32 v25, v34, v35
    v_cvt_pk_bf16_f32 v26, v36, v37
    v_exp_f32 v40, v40
    v_cvt_pk_bf16_f32 v27, v38, v39
    v_mfma_f32_32x32x8_bf16 v[48:63], v[250:251], v[16:17], v[48:63]
    v_exp_f32 v41, v41
    v_exp_f32 v42, v42
    v_exp_f32 v43, v43
    v_exp_f32 v44, v44
    v_mfma_f32_32x32x16_bf16 v[64:79], v[208:211], v[24:27], v[64:79]
    v_exp_f32 v45, v45
    v_exp_f32 v46, v46
    v_exp_f32 v47, v47
    v_cvt_pk_bf16_f32 v28, v40, v41
    v_cvt_pk_bf16_f32 v29, v42, v43
    v_cvt_pk_bf16_f32 v30, v44, v45
    v_cvt_pk_bf16_f32 v31, v46, v47
    v_exp_f32 v48, v48
    v_exp_f32 v49, v49
    v_exp_f32 v50, v50
    v_mfma_f32_32x32x16_bf16 v[64:79], v[212:215], v[28:31], v[64:79]
    s_add_u32 s65, s74, 36864
    buffer_load_dwordx4 v[200:203], v2, s[12:15], s65 offen offset:0 sc1
    v_exp_f32 v51, v51
    v_exp_f32 v52, v52
    v_exp_f32 v53, v53
    v_exp_f32 v54, v54
    v_mfma_f32_32x32x16_bf16 v[32:47], v[168:171], v[12:15], 0
    s_add_u32 s65, s21, 24576
    buffer_load_dwordx4 v[168:171], v2, s[12:15], s65 offen offset:0 sc1
    v_exp_f32 v55, v55
    v_cvt_pk_bf16_f32 v24, v48, v49
    v_cvt_pk_bf16_f32 v25, v50, v51
    v_cvt_pk_bf16_f32 v26, v52, v53
    v_exp_f32 v56, v56
    v_cvt_pk_bf16_f32 v27, v54, v55
    v_mfma_f32_32x32x8_bf16 v[32:47], v[252:253], v[16:17], v[32:47]
    v_exp_f32 v57, v57
    v_exp_f32 v58, v58
    v_exp_f32 v59, v59
    v_exp_f32 v60, v60
    v_mfma_f32_32x32x16_bf16 v[64:79], v[216:219], v[24:27], v[64:79]
    s_add_u32 s65, s21, 36864
    buffer_load_dwordx4 v[204:207], v2, s[12:15], s65 offen offset:0 sc1
    v_exp_f32 v61, v61
    v_exp_f32 v62, v62
    v_exp_f32 v63, v63
    v_cvt_pk_bf16_f32 v28, v56, v57
    v_cvt_pk_bf16_f32 v29, v58, v59
    v_cvt_pk_bf16_f32 v30, v60, v61
    v_cvt_pk_bf16_f32 v31, v62, v63
    s_setprio 1
    v_exp_f32 v32, v32
    v_exp_f32 v33, v33
    v_exp_f32 v34, v34
    v_mfma_f32_32x32x16_bf16 v[64:79], v[220:223], v[28:31], v[64:79]
    v_exp_f32 v35, v35
    v_exp_f32 v36, v36
    v_exp_f32 v37, v37
    v_exp_f32 v38, v38
    v_mfma_f32_32x32x16_bf16 v[48:63], v[172:175], v[12:15], 0
    s_add_u32 s65, s73, 28672
    buffer_load_dwordx4 v[172:175], v2, s[12:15], s65 offen offset:0 sc1
    v_exp_f32 v39, v39
    v_cvt_pk_bf16_f32 v24, v32, v33
    v_cvt_pk_bf16_f32 v25, v34, v35
    v_cvt_pk_bf16_f32 v26, v36, v37
    v_exp_f32 v40, v40
    v_cvt_pk_bf16_f32 v27, v38, v39
    v_mfma_f32_32x32x8_bf16 v[48:63], v[254:255], v[16:17], v[48:63]
    v_exp_f32 v41, v41
    v_exp_f32 v42, v42
    v_exp_f32 v43, v43
    v_exp_f32 v44, v44
    v_mfma_f32_32x32x16_bf16 v[64:79], v[224:227], v[24:27], v[64:79]
    v_exp_f32 v45, v45
    v_exp_f32 v46, v46
    v_exp_f32 v47, v47
    v_cvt_pk_bf16_f32 v28, v40, v41
    v_cvt_pk_bf16_f32 v29, v42, v43
    v_cvt_pk_bf16_f32 v30, v44, v45
    v_cvt_pk_bf16_f32 v31, v46, v47
    s_setprio 0
    v_exp_f32 v48, v48
    v_exp_f32 v49, v49
    v_exp_f32 v50, v50
    v_mfma_f32_32x32x16_bf16 v[64:79], v[228:231], v[28:31], v[64:79]
    v_exp_f32 v51, v51
    v_exp_f32 v52, v52
    v_exp_f32 v53, v53
    v_exp_f32 v54, v54
    s_waitcnt lgkmcnt(0)
    v_exp_f32 v55, v55
    v_cvt_pk_bf16_f32 v24, v48, v49
    v_cvt_pk_bf16_f32 v25, v50, v51
    v_cvt_pk_bf16_f32 v26, v52, v53
    v_exp_f32 v56, v56
    v_cvt_pk_bf16_f32 v27, v54, v55
    v_exp_f32 v57, v57
    v_exp_f32 v58, v58
    v_exp_f32 v59, v59
    v_exp_f32 v60, v60
    v_mfma_f32_32x32x16_bf16 v[64:79], v[232:235], v[24:27], v[64:79]
    v_exp_f32 v61, v61
    v_exp_f32 v62, v62
    v_exp_f32 v63, v63
    v_cvt_pk_bf16_f32 v28, v56, v57
    v_cvt_pk_bf16_f32 v29, v58, v59
    v_cvt_pk_bf16_f32 v30, v60, v61
    v_cvt_pk_bf16_f32 v31, v62, v63
L_att_end:
    s_nop 1
    v_mfma_f32_32x32x16_bf16 v[64:79], v[236:239], v[28:31], v[64:79]
    s_mov_b32 s66, 729808896
    v_mov_b32 v6, 158848
    v_mov_b32 v7, 1
    s_setprio 0
    s_nop 7
    v_pk_add_f32 v[18:19], v[72:73], v[18:19]
    v_pk_add_f32 v[20:21], v[74:75], v[20:21]
    v_pk_add_f32 v[80:81], v[64:65], v[80:81]
    v_pk_add_f32 v[82:83], v[66:67], v[82:83]
    v_pk_add_f32 v[84:85], v[68:69], v[84:85]
    v_pk_add_f32 v[86:87], v[70:71], v[86:87]
    v_mov_b32 v32, v18
    v_mov_b32 v33, v18
    s_nop 1
    v_permlane32_swap_b32 v32, v33
    v_rcp_f32 v34, v33
    v_cmp_nlt_f32 vcc, v33, s30
    v_cmp_ngt_f32 s[68:69], v33, s66
    v_pk_mul_f32 v[40:41], v[80:81], v[34:35] op_sel_hi:[1,0]
    v_pk_mul_f32 v[42:43], v[82:83], v[34:35] op_sel_hi:[1,0]
    v_pk_mul_f32 v[44:45], v[84:85], v[34:35] op_sel_hi:[1,0]
    v_pk_mul_f32 v[46:47], v[86:87], v[34:35] op_sel_hi:[1,0]
    v_pk_mul_f32 v[48:49], v[18:19], v[34:35] op_sel_hi:[1,0]
    v_pk_mul_f32 v[50:51], v[20:21], v[34:35] op_sel_hi:[1,0]
    v_cvt_pk_bf16_f32 v56, v40, v41
    v_cvt_pk_bf16_f32 v57, v42, v43
    v_cvt_pk_bf16_f32 v58, v44, v45
    v_cvt_pk_bf16_f32 v59, v46, v47
    v_cvt_pk_bf16_f32 v60, v48, v49
    v_cvt_pk_bf16_f32 v61, v50, v51
    v_min_u32 v56, -2, v56
    v_min_u32 v57, -2, v57
    v_min_u32 v58, -2, v58
    v_min_u32 v59, -2, v59
    v_min_u32 v60, -2, v60
    v_min_u32 v61, -2, v61
    s_or_b64 vcc, vcc, s[68:69]
    s_cbranch_vccnz L_o_bad
L_o_ok:
    s_cmp_eq_u32 s63, 0
    s_cbranch_scc1 L_ps_43
    buffer_store_dwordx4 v[56:59], v5, s[12:15], s56 offen
    s_mov_b32 exec_hi, 0
    buffer_store_dwordx2 v[60:61], v5, s[12:15], s57 offen
L_pj_44:
    s_mov_b64 exec, -1
L_o_st:
    ds_read_b128 v[80:83], v22
    ds_read_b64 v[84:85], v22 offset:1024
    ds_read_b128 v[32:35], v3 offset:0
    ds_read_b128 v[36:39], v3 offset:1024
    ds_read_b128 v[40:43], v3 offset:2048
    ds_read_b128 v[44:47], v3 offset:3072
    ds_read_b128 v[48:51], v3 offset:4096
    ds_read_b128 v[52:55], v3 offset:5120
    ds_read_b128 v[56:59], v3 offset:6144
    s_waitcnt lgkmcnt(7)
    s_barrier
    ds_read_b32 v7, v6
    s_waitcnt vmcnt(0)
    buffer_load_dwordx4 v[208:211], v2, s[12:15], s16 offen offset:0 sc1
    buffer_load_dwordx4 v[212:215], v2, s[12:15], s16 offen offset:1024 sc1
    buffer_load_dwordx4 v[216:219], v2, s[12:15], s16 offen offset:2048 sc1
    buffer_load_dwordx4 v[220:223], v2, s[12:15], s16 offen offset:3072 sc1
    s_waitcnt lgkmcnt(0)
    v_readfirstlane_b32 s64, v7
    s_nop 0
    s_cmp_gt_u32 s64, s61
    s_cbranch_scc1 L_fallback
    s_mul_i32 s64, s49, 5120
    s_add_u32 s64, s64, 102400
    v_add_u32 v6, s64, v2
    s_mul_i32 s64, s49, 2688
    s_add_u32 s64, s64, 86016
    v_and_b32 v8, 15, v1
    v_mul_u32_u24 v8, 168, v8
    v_lshrrev_b32 v9, 4, v1
    v_lshl_add_u32 v8, v9, 3, v8
    v_add_u32 v8, s64, v8
    s_mul_i32 s64, s48, 192
    s_add_u32 s64, s64, 160512
    v_lshl_add_u32 v5, v9, 4, s64
    v_mov_b32 v248, s60
    v_mov_b32 v249, s60
    v_mov_b32 v250, s60
    v_mov_b32 v251, s60
    s_nop 1
    v_mfma_f32_16x16x32_bf16 v[12:15], v[88:91], v[248:251], 0
    v_mfma_f32_16x16x32_bf16 v[12:15], v[100:103], v[248:251], v[12:15]
    v_mfma_f32_16x16x32_bf16 v[12:15], v[112:115], v[248:251], v[12:15]
    v_mfma_f32_16x16x32_bf16 v[12:15], v[124:127], v[248:251], v[12:15]
    v_mfma_f32_16x16x32_bf16 v[12:15], v[136:139], v[248:251], v[12:15]
    v_mfma_f32_16x16x32_bf16 v[12:15], v[148:151], v[248:251], v[12:15]
    v_mfma_f32_16x16x32_bf16 v[12:15], v[160:163], v[248:251], v[12:15]
    v_mfma_f32_16x16x32_bf16 v[12:15], v[172:175], v[248:251], v[12:15]
    v_mfma_f32_16x16x32_bf16 v[12:15], v[184:187], v[248:251], v[12:15]
    v_mfma_f32_16x16x32_bf16 v[12:15], v[196:199], v[248:251], v[12:15]
    s_nop 7
    ds_write_b128 v5, v[12:15] offset:0
    s_setprio 3
    buffer_load_dwordx4 v[224:227], v2, s[12:15], s33 offen offset:0 sc1
    buffer_load_dwordx4 v[228:231], v2, s[12:15], s33 offen offset:1024 sc1
    s_waitcnt vmcnt(4)
    v_max_u32 v11, v208, v212
    v_cmp_eq_u32 vcc, -1, v11
    s_cbranch_vccnz L_O0
L_O0_x:
    s_waitcnt lgkmcnt(7)
    v_mfma_f32_16x16x32_bf16 v[12:15], v[32:35], v[208:211], 0
    ds_read_b128 v[60:63], v3 offset:7168
    v_mfma_f32_16x16x32_bf16 v[16:19], v[36:39], v[208:211], 0
    ds_read_b128 v[32:35], v3 offset:8192
    s_waitcnt lgkmcnt(7)
    v_mfma_f32_16x16x32_bf16 v[20:23], v[40:43], v[208:211], 0
    ds_read_b128 v[36:39], v3 offset:9216
    v_mfma_f32_16x16x32_bf16 v[24:27], v[44:47], v[208:211], 0
    ds_read_b128 v[40:43], v3 offset:10240
    s_waitcnt lgkmcnt(7)
    v_mfma_f32_16x16x32_bf16 v[28:31], v[48:51], v[208:211], 0
    ds_read_b128 v[44:47], v3 offset:11264
    v_mfma_f32_16x16x32_bf16 v[12:15], v[52:55], v[212:215], v[12:15]
    ds_read_b128 v[48:51], v3 offset:12288
    s_waitcnt lgkmcnt(5)
    v_mfma_f32_16x16x32_bf16 v[16:19], v[56:59], v[212:215], v[16:19]
    ds_read_b128 v[52:55], v3 offset:13312
    v_mfma_f32_16x16x32_bf16 v[20:23], v[60:63], v[212:215], v[20:23]
    ds_read_b128 v[56:59], v3 offset:14336
    s_waitcnt lgkmcnt(5)
    v_mfma_f32_16x16x32_bf16 v[24:27], v[32:35], v[212:215], v[24:27]
    ds_read_b128 v[60:63], v3 offset:15360
    v_mfma_f32_16x16x32_bf16 v[28:31], v[36:39], v[212:215], v[28:31]
    ds_read_b128 v[32:35], v3 offset:16384
    buffer_load_dwordx4 v[232:235], v2, s[12:15], s33 offen offset:2048 sc1
    buffer_load_dwordx4 v[236:239], v2, s[12:15], s33 offen offset:3072 sc1
    s_waitcnt vmcnt(4)
    v_max_u32 v11, v216, v220
    v_cmp_eq_u32 vcc, -1, v11
    s_cbranch_vccnz L_O2
L_O2_x:
    s_waitcnt lgkmcnt(5)
    v_mfma_f32_16x16x32_bf16 v[12:15], v[40:43], v[216:219], v[12:15]
    ds_read_b128 v[36:39], v3 offset:17408
    v_mfma_f32_16x16x32_bf16 v[16:19], v[44:47], v[216:219], v[16:19]
    ds_read_b128 v[40:43], v3 offset:18432
    s_waitcnt lgkmcnt(5)
    v_mfma_f32_16x16x32_bf16 v[20:23], v[48:51], v[216:219], v[20:23]
    ds_read_b128 v[44:47], v3 offset:19456
    v_mfma_f32_16x16x32_bf16 v[24:27], v[52:55], v[216:219], v[24:27]
    ds_read_b128 v[48:51], v3 offset:20480
    s_waitcnt lgkmcnt(5)
    v_mfma_f32_16x16x32_bf16 v[28:31], v[56:59], v[216:219], v[28:31]
    ds_read_b128 v[52:55], v3 offset:21504
    v_mfma_f32_16x16x32_bf16 v[12:15], v[60:63], v[220:223], v[12:15]
    ds_read_b128 v[56:59], v3 offset:22528
    s_waitcnt lgkmcnt(5)
    v_mfma_f32_16x16x32_bf16 v[16:19], v[32:35], v[220:223], v[16:19]
    ds_read_b128 v[60:63], v3 offset:23552
    v_mfma_f32_16x16x32_bf16 v[20:23], v[36:39], v[220:223], v[20:23]
    ds_read_b128 v[32:35], v3 offset:24576
    s_waitcnt lgkmcnt(5)
    v_mfma_f32_16x16x32_bf16 v[24:27], v[40:43], v[220:223], v[24:27]
    ds_read_b128 v[36:39], v3 offset:25600
    v_mfma_f32_16x16x32_bf16 v[28:31], v[44:47], v[220:223], v[28:31]
    ds_read_b128 v[40:43], v3 offset:26624
    s_setprio 2
    buffer_load_dwordx4 v[240:243], v2, s[12:15], s78 offen offset:0 sc1
    buffer_load_dwordx4 v[244:247], v2, s[12:15], s78 offen offset:1024 sc1
    s_waitcnt vmcnt(4)
    v_max_u32 v11, v224, v228
    v_cmp_eq_u32 vcc, -1, v11
    s_cbranch_vccnz L_O4
L_O4_x:
    s_waitcnt lgkmcnt(5)
    v_mfma_f32_16x16x32_bf16 v[12:15], v[48:51], v[224:227], v[12:15]
    ds_read_b128 v[44:47], v3 offset:27648
    v_mfma_f32_16x16x32_bf16 v[16:19], v[52:55], v[224:227], v[16:19]
    ds_read_b128 v[48:51], v3 offset:28672
    s_waitcnt lgkmcnt(5)
    v_mfma_f32_16x16x32_bf16 v[20:23], v[56:59], v[224:227], v[20:23]
    buffer_load_dwordx4 v[64:67], v2, s[12:15], s42 offen offset:0 sc1
    ds_read_b128 v[52:55], v3 offset:29696
    v_mfma_f32_16x16x32_bf16 v[24:27], v[60:63], v[224:227], v[24:27]
    ds_read_b128 v[56:59], v3 offset:30720
    s_waitcnt lgkmcnt(5)
    v_mfma_f32_16x16x32_bf16 v[28:31], v[32:35], v[224:227], v[28:31]
    ds_read_b128 v[60:63], v3 offset:31744
    v_mfma_f32_16x16x32_bf16 v[12:15], v[36:39], v[228:231], v[12:15]
    ds_read_b128 v[32:35], v3 offset:32768
    s_waitcnt lgkmcnt(5)
    v_mfma_f32_16x16x32_bf16 v[16:19], v[40:43], v[228:231], v[16:19]
    s_add_u32 s65, s42, 40960
    buffer_load_dwordx4 v[68:71], v2, s[12:15], s65 offen offset:0 sc1
    ds_read_b128 v[36:39], v3 offset:33792
    v_mfma_f32_16x16x32_bf16 v[20:23], v[44:47], v[228:231], v[20:23]
    ds_read_b128 v[40:43], v3 offset:34816
    s_waitcnt lgkmcnt(5)
    v_mfma_f32_16x16x32_bf16 v[24:27], v[48:51], v[228:231], v[24:27]
    ds_read_b128 v[44:47], v3 offset:35840
    v_mfma_f32_16x16x32_bf16 v[28:31], v[52:55], v[228:231], v[28:31]
    ds_read_b128 v[48:51], v3 offset:36864
    s_waitcnt vmcnt(4)
    v_max_u32 v11, v232, v236
    v_cmp_eq_u32 vcc, -1, v11
    s_cbranch_vccnz L_O6
L_O6_x:
    s_waitcnt lgkmcnt(5)
    v_mfma_f32_16x16x32_bf16 v[12:15], v[56:59], v[232:235], v[12:15]
    s_add_u32 s65, s42, 81920
    buffer_load_dwordx4 v[72:75], v2, s[12:15], s65 offen offset:0 sc1
    ds_read_b128 v[52:55], v3 offset:37888
    v_mfma_f32_16x16x32_bf16 v[16:19], v[60:63], v[232:235], v[16:19]
    ds_read_b128 v[56:59], v3 offset:38912
    s_waitcnt lgkmcnt(5)
    v_mfma_f32_16x16x32_bf16 v[20:23], v[32:35], v[232:235], v[20:23]
    ds_read_b128 v[60:63], v3 offset:39936
    v_mfma_f32_16x16x32_bf16 v[24:27], v[36:39], v[232:235], v[24:27]
    ds_read_b128 v[32:35], v3 offset:40960
    s_waitcnt lgkmcnt(5)
    v_mfma_f32_16x16x32_bf16 v[28:31], v[40:43], v[232:235], v[28:31]
    ds_read_b128 v[36:39], v3 offset:41984
    s_setprio 1
    v_mfma_f32_16x16x32_bf16 v[12:15], v[44:47], v[236:239], v[12:15]
    s_add_u32 s65, s42, 122880
    buffer_load_dwordx4 v[76:79], v2, s[12:15], s65 offen offset:0 sc1
    ds_read_b128 v[40:43], v3 offset:43008
    s_waitcnt lgkmcnt(5)
    v_mfma_f32_16x16x32_bf16 v[16:19], v[48:51], v[236:239], v[16:19]
    ds_read_b128 v[44:47], v3 offset:44032
    v_mfma_f32_16x16x32_bf16 v[20:23], v[52:55], v[236:239], v[20:23]
    ds_read_b128 v[48:51], v3 offset:45056
    s_waitcnt lgkmcnt(5)
    v_mfma_f32_16x16x32_bf16 v[24:27], v[56:59], v[236:239], v[24:27]
    ds_read_b128 v[52:55], v3 offset:46080
    v_mfma_f32_16x16x32_bf16 v[28:31], v[60:63], v[236:239], v[28:31]
    s_add_u32 s65, s42, 163840
    buffer_load_dwordx4 v[208:211], v2, s[12:15], s65 offen offset:0 sc1
    ds_read_b128 v[56:59], v3 offset:47104
    s_waitcnt vmcnt(5)
    v_max3_u32 v11, v240, v242, v244
    v_max_u32 v11, v11, v246
    v_cmp_eq_u32 vcc, -1, v11
    s_cbranch_vccnz L_O8
L_O8_x:
    s_waitcnt lgkmcnt(5)
    v_mfma_f32_16x16x32_bf16 v[12:15], v[32:35], v[240:243], v[12:15]
    ds_read_b128 v[60:63], v3 offset:48128
    v_mfma_f32_16x16x32_bf16 v[16:19], v[36:39], v[240:243], v[16:19]
    ds_read_b128 v[32:35], v3 offset:49152
    s_waitcnt lgkmcnt(5)
    v_mfma_f32_16x16x32_bf16 v[20:23], v[40:43], v[240:243], v[20:23]
    ds_read_b128 v[36:39], v3 offset:50176
    v_mfma_f32_16x16x32_bf16 v[24:27], v[44:47], v[240:243], v[24:27]
    s_add_u32 s65, s42, 204800
    buffer_load_dwordx4 v[212:215], v2, s[12:15], s65 offen offset:0 sc1
    s_waitcnt lgkmcnt(4)
    v_mfma_f32_16x16x32_bf16 v[28:31], v[48:51], v[240:243], v[28:31]
    s_setprio 0
    v_mfma_f32_16x16x32_bf16 v[12:15], v[52:55], v[244:247], v[12:15]
    s_waitcnt lgkmcnt(2)
    v_mfma_f32_16x16x32_bf16 v[16:19], v[56:59], v[244:247], v[16:19]
    v_mfma_f32_16x16x32_bf16 v[20:23], v[60:63], v[244:247], v[20:23]
    s_waitcnt lgkmcnt(0)
    v_mfma_f32_16x16x32_bf16 v[24:27], v[32:35], v[244:247], v[24:27]
    v_mfma_f32_16x16x32_bf16 v[28:31], v[36:39], v[244:247], v[28:31]
    v_lshlrev_b32 v32, 16, v80
    v_and_b32 v33, 0xffff0000, v80
    v_lshlrev_b32 v34, 16, v81
    v_and_b32 v35, 0xffff0000, v81
    v_lshlrev_b32 v36, 16, v82
    v_and_b32 v37, 0xffff0000, v82
    v_lshlrev_b32 v38, 16, v83
    v_and_b32 v39, 0xffff0000, v83
    v_lshlrev_b32 v40, 16, v84
    v_and_b32 v41, 0xffff0000, v84
    v_lshlrev_b32 v42, 16, v85
    v_and_b32 v43, 0xffff0000, v85
    s_cmp_lg_u32 s50, 0
    s_cbranch_scc1 L_e1
    ds_write_b128 v6, v[20:23] offset:2048
    ds_write_b128 v6, v[24:27] offset:3072
    v_pk_add_f32 v[12:13], v[12:13], v[32:33]
    v_pk_add_f32 v[14:15], v[14:15], v[34:35]
    v_pk_add_f32 v[16:17], v[16:17], v[36:37]
    v_pk_add_f32 v[18:19], v[18:19], v[38:39]
    v_pk_add_f32 v[28:29], v[28:29], v[40:41]
    v_pk_add_f32 v[30:31], v[30:31], v[42:43]
    s_waitcnt lgkmcnt(0)
    s_barrier
    ds_read_b128 v[44:47], v6 offset:0
    ds_read_b128 v[48:51], v6 offset:1024
    ds_read_b128 v[52:55], v6 offset:4096
    s_waitcnt lgkmcnt(2)
    v_pk_add_f32 v[12:13], v[12:13], v[44:45]
    v_pk_add_f32 v[14:15], v[14:15], v[46:47]
    v_cvt_pk_bf16_f32 v80, v12, v13
    v_cvt_pk_bf16_f32 v81, v14, v15
    v_min_u32 v80, -2, v80
    v_min_u32 v81, -2, v81
    s_waitcnt lgkmcnt(1)
    v_pk_add_f32 v[16:17], v[16:17], v[48:49]
    v_pk_add_f32 v[18:19], v[18:19], v[50:51]
    v_cvt_pk_bf16_f32 v82, v16, v17
    v_cvt_pk_bf16_f32 v83, v18, v19
    v_min_u32 v82, -2, v82
    v_min_u32 v83, -2, v83
    s_waitcnt lgkmcnt(0)
    v_pk_add_f32 v[28:29], v[28:29], v[52:53]
    v_pk_add_f32 v[30:31], v[30:31], v[54:55]
    v_cvt_pk_bf16_f32 v84, v28, v29
    v_cvt_pk_bf16_f32 v85, v30, v31
    v_min_u32 v84, -2, v84
    v_min_u32 v85, -2, v85
    s_cmp_eq_u32 s63, 0
    s_cbranch_scc1 L_ps_45
    buffer_store_dwordx4 v[80:83], v2, s[12:15], s17 offen
    buffer_store_dwordx2 v[84:85], v2, s[12:15], s18 offen
L_pj_46:
    ds_write_b64 v8, v[80:81] offset:0
    ds_write_b64 v8, v[82:83] offset:32
    ds_write_b64 v8, v[84:85] offset:128
    s_branch L_e_j
L_e1:
    ds_write_b128 v6, v[12:15] offset:0
    ds_write_b128 v6, v[16:19] offset:1024
    ds_write_b128 v6, v[28:31] offset:4096
    v_pk_add_f32 v[20:21], v[20:21], v[32:33]
    v_pk_add_f32 v[22:23], v[22:23], v[34:35]
    v_pk_add_f32 v[24:25], v[24:25], v[36:37]
    v_pk_add_f32 v[26:27], v[26:27], v[38:39]
    s_waitcnt lgkmcnt(0)
    s_barrier
    ds_read_b128 v[44:47], v6 offset:2048
    ds_read_b128 v[48:51], v6 offset:3072
    s_waitcnt lgkmcnt(1)
    v_pk_add_f32 v[20:21], v[20:21], v[44:45]
    v_pk_add_f32 v[22:23], v[22:23], v[46:47]
    v_cvt_pk_bf16_f32 v80, v20, v21
    v_cvt_pk_bf16_f32 v81, v22, v23
    v_min_u32 v80, -2, v80
    v_min_u32 v81, -2, v81
    s_waitcnt lgkmcnt(0)
    v_pk_add_f32 v[24:25], v[24:25], v[48:49]
    v_pk_add_f32 v[26:27], v[26:27], v[50:51]
    v_cvt_pk_bf16_f32 v82, v24, v25
    v_cvt_pk_bf16_f32 v83, v26, v27
    v_min_u32 v82, -2, v82
    v_min_u32 v83, -2, v83
    s_cmp_eq_u32 s63, 0
    s_cbranch_scc1 L_ps_47
    buffer_store_dwordx4 v[80:83], v2, s[12:15], s17 offen
L_pj_48:
    ds_write_b64 v8, v[80:81] offset:64
    ds_write_b64 v8, v[82:83] offset:96
L_e_j:
    v_mov_b32 v244, s60
    v_mov_b32 v245, s60
    v_mov_b32 v246, s60
    v_mov_b32 v247, s60
    s_nop 1
    v_mfma_f32_16x16x32_bf16 v[56:59], v[92:95], v[244:247], 0
    s_add_u32 s16, s16, 81920
    s_add_u32 s33, s33, 81920
    v_mfma_f32_16x16x32_bf16 v[60:63], v[96:99], v[244:247], 0
    s_add_u32 s78, s78, 81920
    v_mfma_f32_16x16x32_bf16 v[56:59], v[104:107], v[244:247], v[56:59]
    v_add_u32 v7, s79, v2
    s_mul_i32 s64, s50, 30720
    v_mfma_f32_16x16x32_bf16 v[60:63], v[108:111], v[244:247], v[60:63]
    v_add_u32 v8, s64, v2
    v_mfma_f32_16x16x32_bf16 v[56:59], v[116:119], v[244:247], v[56:59]
    s_mul_i32 s64, s50, -10240
    s_add_u32 s64, s64, 20480
    v_mfma_f32_16x16x32_bf16 v[60:63], v[120:123], v[244:247], v[60:63]
    v_add_u32 v9, s64, v2
    s_waitcnt vmcnt(0)
    v_mfma_f32_16x16x32_bf16 v[56:59], v[128:131], v[244:247], v[56:59]
    s_add_u32 m0, s79, 0
    s_nop 0
    buffer_load_dwordx4 v2, s[12:15], s16 offen offset:0 sc1 lds
    v_mfma_f32_16x16x32_bf16 v[60:63], v[132:135], v[244:247], v[60:63]
    s_add_u32 m0, s79, 0
    s_nop 0
    buffer_load_dwordx4 v2, s[12:15], s16 offen offset:1024 sc1 lds
    v_mfma_f32_16x16x32_bf16 v[56:59], v[140:143], v[244:247], v[56:59]
    v_mfma_f32_16x16x32_bf16 v[60:63], v[144:147], v[244:247], v[60:63]
    s_add_u32 m0, s79, 0
    s_nop 0
    buffer_load_dwordx4 v2, s[12:15], s16 offen offset:2048 sc1 lds
    v_mfma_f32_16x16x32_bf16 v[56:59], v[152:155], v[244:247], v[56:59]
    s_add_u32 m0, s79, 0
    s_nop 0
    buffer_load_dwordx4 v2, s[12:15], s16 offen offset:3072 sc1 lds
    s_lshl_b32 s64, s48, 10
    s_add_u32 s64, s64, 147456
    v_mfma_f32_16x16x32_bf16 v[60:63], v[156:159], v[244:247], v[60:63]
    v_add_u32 v6, s64, v2
    v_lshl_add_u32 v10, v1, 2, s64
    v_mfma_f32_16x16x32_bf16 v[56:59], v[164:167], v[244:247], v[56:59]
    v_and_b32 v3, 15, v1
    v_mfma_f32_16x16x32_bf16 v[60:63], v[168:171], v[244:247], v[60:63]
    v_lshrrev_b32 v0, 2, v3
    v_lshl_add_u32 v0, v0, 4, v3
    v_mfma_f32_16x16x32_bf16 v[56:59], v[176:179], v[244:247], v[56:59]
    v_lshlrev_b32 v0, 2, v0
    v_mfma_f32_16x16x32_bf16 v[60:63], v[180:183], v[244:247], v[60:63]
    v_and_b32 v4, 3, v3
    v_add_u32 v0, v0, v4
    v_mfma_f32_16x16x32_bf16 v[56:59], v[188:191], v[244:247], v[56:59]
    s_lshl_b32 s64, s50, 10
    s_add_u32 s64, s64, 147456
    v_mfma_f32_16x16x32_bf16 v[60:63], v[192:195], v[244:247], v[60:63]
    v_lshl_add_u32 v0, v0, 2, s64
    v_mfma_f32_16x16x32_bf16 v[56:59], v[200:203], v[244:247], v[56:59]
    s_add_u32 s64, s64, 64
    v_lshl_add_u32 v3, v3, 2, s64
    v_mfma_f32_16x16x32_bf16 v[60:63], v[204:207], v[244:247], v[60:63]
    v_xor_b32 v4, 1024, v3
    s_nop 3
    ds_write_b128 v5, v[56:59] offset:64
    s_nop 1
    ds_write_b128 v5, v[60:63] offset:128
    s_add_u32 m0, s79, 4096
    s_nop 0
    buffer_load_dwordx4 v2, s[12:15], s33 offen offset:0 sc1 lds
    s_add_u32 m0, s79, 4096
    s_nop 0
    buffer_load_dwordx4 v2, s[12:15], s33 offen offset:1024 sc1 lds
    s_waitcnt vmcnt(4)
    ds_read_b128 v[36:39], v7 offset:0
    ds_read_b128 v[40:43], v7 offset:1024
    s_waitcnt vmcnt(2)
    ds_read_b128 v[44:47], v7 offset:2048
    ds_read_b128 v[48:51], v7 offset:3072
    s_add_u32 m0, s79, 4096
    s_nop 0
    buffer_load_dwordx4 v2, s[12:15], s33 offen offset:2048 sc1 lds
    s_waitcnt lgkmcnt(2)
    v_max_u32 v11, v36, v40
    v_cmp_eq_u32 vcc, -1, v11
    s_cbranch_vccnz L_H0
L_H0_x:
    s_waitcnt lgkmcnt(0)
    v_max_u32 v11, v44, v48
    v_cmp_eq_u32 vcc, -1, v11
    s_cbranch_vccnz L_H2
L_H2_x:
    s_barrier
    ds_read_b128 v[60:63], v8 offset:0
    ds_read_b128 v[80:83], v9 offset:0
    ds_read_b128 v[84:87], v8 offset:40960
    ds_read_b128 v[248:251], v9 offset:40960
    v_mfma_f32_16x16x32_bf16 v[236:239], v[244:247], v[36:39], 0
    v_mfma_f32_16x16x32_bf16 v[240:243], v[36:39], v[36:39], 0
    v_mfma_f32_16x16x32_bf16 v[236:239], v[244:247], v[40:43], v[236:239]
    v_mfma_f32_16x16x32_bf16 v[240:243], v[40:43], v[40:43], v[240:243]
    v_mfma_f32_16x16x32_bf16 v[236:239], v[244:247], v[44:47], v[236:239]
    v_mfma_f32_16x16x32_bf16 v[240:243], v[44:47], v[44:47], v[240:243]
    v_mfma_f32_16x16x32_bf16 v[236:239], v[244:247], v[48:51], v[236:239]
    v_mfma_f32_16x16x32_bf16 v[240:243], v[48:51], v[48:51], v[240:243]
    s_setprio 3
    s_waitcnt lgkmcnt(3)
    s_add_u32 m0, s79, 4096
    s_nop 0
    buffer_load_dwordx4 v2, s[12:15], s33 offen offset:3072 sc1 lds
    v_mfma_f32_16x16x32_bf16 v[12:15], v[88:91], v[60:63], 0
    s_add_u32 m0, s79, 8192
    s_nop 0
    buffer_load_dwordx4 v2, s[12:15], s78 offen offset:0 sc1 lds
    v_mfma_f32_16x16x32_bf16 v[16:19], v[92:95], v[60:63], 0
    s_add_u32 m0, s79, 8192
    s_nop 0
    buffer_load_dwordx4 v2, s[12:15], s78 offen offset:1024 sc1 lds
    v_mfma_f32_16x16x32_bf16 v[20:23], v[96:99], v[60:63], 0
    s_waitcnt vmcnt(4)
    ds_read_b128 v[252:255], v8 offset:1024
    s_waitcnt lgkmcnt(3)
    ds_read_b128 v[228:231], v7 offset:4096
    v_mfma_f32_16x16x32_bf16 v[24:27], v[88:91], v[80:83], 0
    ds_read_b128 v[232:235], v7 offset:5120
    v_mfma_f32_16x16x32_bf16 v[28:31], v[92:95], v[80:83], 0
    v_mfma_f32_16x16x32_bf16 v[32:35], v[96:99], v[80:83], 0
    ds_read_b128 v[60:63], v9 offset:1024
    s_waitcnt lgkmcnt(5)
    v_mfma_f32_16x16x32_bf16 v[36:39], v[88:91], v[84:87], 0
    v_mfma_f32_16x16x32_bf16 v[40:43], v[92:95], v[84:87], 0
    s_waitcnt lgkmcnt(1)
    v_mfma_f32_16x16x32_bf16 v[44:47], v[96:99], v[84:87], 0
    ds_read_b128 v[80:83], v8 offset:41984
    v_max_u32 v11, v228, v232
    s_waitcnt lgkmcnt(5)
    v_cmp_eq_u32 vcc, -1, v11
    v_mfma_f32_16x16x32_bf16 v[48:51], v[88:91], v[248:251], 0
    s_cbranch_vccnz L_H4
L_H4_x:
    v_mfma_f32_16x16x32_bf16 v[52:55], v[92:95], v[248:251], 0
    v_mfma_f32_16x16x32_bf16 v[236:239], v[244:247], v[228:231], v[236:239]
    v_mfma_f32_16x16x32_bf16 v[56:59], v[96:99], v[248:251], 0
    ds_read_b128 v[84:87], v9 offset:41984
    v_mfma_f32_16x16x32_bf16 v[240:243], v[228:231], v[228:231], v[240:243]
    s_waitcnt lgkmcnt(5)
    v_mfma_f32_16x16x32_bf16 v[236:239], v[244:247], v[232:235], v[236:239]
    s_mul_i32 s65, s48, 3072
    s_add_u32 m0, s65, 122880
    s_add_u32 s65, s42, 86016
    buffer_load_dwordx4 v2, s[12:15], s65 offen sc1 lds
    v_mfma_f32_16x16x32_bf16 v[240:243], v[232:235], v[232:235], v[240:243]
    v_mfma_f32_16x16x32_bf16 v[12:15], v[100:103], v[252:255], v[12:15]
    v_mfma_f32_16x16x32_bf16 v[16:19], v[104:107], v[252:255], v[16:19]
    s_waitcnt vmcnt(3)
    v_mfma_f32_16x16x32_bf16 v[20:23], v[108:111], v[252:255], v[20:23]
    ds_read_b128 v[228:231], v7 offset:6144
    s_mul_i32 s65, s48, 3072
    s_add_u32 m0, s65, 123904
    s_add_u32 s65, s42, 126976
    buffer_load_dwordx4 v2, s[12:15], s65 offen sc1 lds
    ds_read_b128 v[232:235], v7 offset:7168
    ds_read_b128 v[248:251], v8 offset:2048
    s_waitcnt lgkmcnt(5)
    v_mfma_f32_16x16x32_bf16 v[24:27], v[100:103], v[60:63], v[24:27]
    s_mul_i32 s65, s48, 3072
    s_add_u32 m0, s65, 124928
    s_add_u32 s65, s42, 167936
    buffer_load_dwordx4 v2, s[12:15], s65 offen sc1 lds
    v_mfma_f32_16x16x32_bf16 v[28:31], v[104:107], v[60:63], v[28:31]
    v_mfma_f32_16x16x32_bf16 v[32:35], v[108:111], v[60:63], v[32:35]
    s_waitcnt lgkmcnt(1)
    ds_read_b128 v[252:255], v9 offset:2048
    s_waitcnt lgkmcnt(5)
    v_max_u32 v11, v228, v232
    s_add_u32 s65, s42, 81920
    buffer_load_dwordx4 v[88:91], v2, s[12:15], s65 offen offset:2048 sc1
    v_cmp_eq_u32 vcc, -1, v11
    v_mfma_f32_16x16x32_bf16 v[36:39], v[100:103], v[80:83], v[36:39]
    s_cbranch_vccnz L_H6
L_H6_x:
    v_mfma_f32_16x16x32_bf16 v[40:43], v[104:107], v[80:83], v[40:43]
    v_mfma_f32_16x16x32_bf16 v[44:47], v[108:111], v[80:83], v[44:47]
    s_setprio 2
    v_mfma_f32_16x16x32_bf16 v[236:239], v[244:247], v[228:231], v[236:239]
    s_add_u32 s65, s42, 122880
    buffer_load_dwordx4 v[92:95], v2, s[12:15], s65 offen offset:2048 sc1
    v_mfma_f32_16x16x32_bf16 v[240:243], v[228:231], v[228:231], v[240:243]
    ds_read_b128 v[60:63], v8 offset:43008
    v_mfma_f32_16x16x32_bf16 v[236:239], v[244:247], v[232:235], v[236:239]
    s_waitcnt lgkmcnt(5)
    v_mfma_f32_16x16x32_bf16 v[240:243], v[232:235], v[232:235], v[240:243]
    v_mfma_f32_16x16x32_bf16 v[48:51], v[100:103], v[84:87], v[48:51]
    s_add_u32 s65, s42, 163840
    buffer_load_dwordx4 v[96:99], v2, s[12:15], s65 offen offset:2048 sc1
    s_waitcnt vmcnt(6)
    v_mfma_f32_16x16x32_bf16 v[52:55], v[104:107], v[84:87], v[52:55]
    ds_read_b128 v[228:231], v7 offset:8192
    v_mfma_f32_16x16x32_bf16 v[56:59], v[108:111], v[84:87], v[56:59]
    ds_read_b128 v[232:235], v7 offset:9216
    ds_read_b128 v[80:83], v9 offset:43008
    s_waitcnt lgkmcnt(5)
    s_add_u32 s65, s42, 204800
    buffer_load_dwordx4 v[100:103], v2, s[12:15], s65 offen offset:2048 sc1
    v_mfma_f32_16x16x32_bf16 v[12:15], v[112:115], v[248:251], v[12:15]
    v_mfma_f32_16x16x32_bf16 v[16:19], v[116:119], v[248:251], v[16:19]
    v_mfma_f32_16x16x32_bf16 v[20:23], v[120:123], v[248:251], v[20:23]
    ds_read_b128 v[84:87], v8 offset:3072
    s_setprio 1
    s_waitcnt lgkmcnt(2)
    s_waitcnt lgkmcnt(5)
    v_max3_u32 v11, v228, v230, v232
    v_mfma_f32_16x16x32_bf16 v[24:27], v[112:115], v[252:255], v[24:27]
    v_max_u32 v11, v11, v234
    buffer_load_dwordx4 v[104:107], v2, s[12:15], s42 offen offset:3072 sc1
    v_cmp_eq_u32 vcc, -1, v11
    v_mfma_f32_16x16x32_bf16 v[28:31], v[116:119], v[252:255], v[28:31]
    v_mfma_f32_16x16x32_bf16 v[32:35], v[120:123], v[252:255], v[32:35]
    s_cbranch_vccnz L_H8
L_H8_x:
    ds_read_b128 v[248:251], v9 offset:3072
    v_mfma_f32_16x16x32_bf16 v[236:239], v[244:247], v[228:231], v[236:239]
    s_waitcnt lgkmcnt(5)
    v_mfma_f32_16x16x32_bf16 v[240:243], v[228:231], v[228:231], v[240:243]
    v_mfma_f32_16x16x32_bf16 v[36:39], v[112:115], v[60:63], v[36:39]
    v_mfma_f32_16x16x32_bf16 v[40:43], v[116:119], v[60:63], v[40:43]
    v_mfma_f32_16x16x32_bf16 v[236:239], v[244:247], v[232:235], v[236:239]
    v_mfma_f32_16x16x32_bf16 v[44:47], v[120:123], v[60:63], v[44:47]
    s_setprio 0
    v_mfma_f32_16x16x32_bf16 v[240:243], v[232:235], v[232:235], v[240:243]
    s_add_u32 s65, s42, 40960
    buffer_load_dwordx4 v[108:111], v2, s[12:15], s65 offen offset:3072 sc1
    ds_read_b128 v[252:255], v8 offset:44032
    s_waitcnt lgkmcnt(3)
    v_mfma_f32_16x16x32_bf16 v[48:51], v[112:115], v[80:83], v[48:51]
    v_mfma_f32_16x16x32_bf16 v[52:55], v[116:119], v[80:83], v[52:55]
    s_nop 1
    ds_write_b128 v6, v[240:243]
    v_mfma_f32_16x16x32_bf16 v[56:59], v[120:123], v[80:83], v[56:59]
    ds_write_b32 v10, v236 offset:64
    ds_read_b128 v[60:63], v9 offset:44032
    s_waitcnt lgkmcnt(1)
    s_barrier
    s_setprio 3
    s_waitcnt lgkmcnt(5)
    buffer_load_dwordx4 v[216:219], v2, s[12:15], s42 offen offset:1024 sc1
    ds_read2st64_b32 v[112:113], v3 offset0:0 offset1:16
    ds_read2st64_b32 v[114:115], v4 offset0:0 offset1:16
    ds_read2st64_b32 v[116:117], v3 offset0:8 offset1:24
    v_mfma_f32_16x16x32_bf16 v[12:15], v[124:127], v[84:87], v[12:15]
    ds_read2st64_b32 v[118:119], v4 offset0:8 offset1:24
    ds_read2st64_b32 v[120:121], v0 offset0:0 offset1:16
    v_mfma_f32_16x16x32_bf16 v[16:19], v[128:131], v[84:87], v[16:19]
    ds_read2st64_b32 v[122:123], v0 offset0:8 offset1:24
    v_mfma_f32_16x16x32_bf16 v[20:23], v[132:135], v[84:87], v[20:23]
    s_add_u32 s65, s42, 40960
    buffer_load_dwordx4 v[220:223], v2, s[12:15], s65 offen offset:1024 sc1
    ds_read_b128 v[80:83], v8 offset:4096
    s_waitcnt lgkmcnt(11)
    v_mfma_f32_16x16x32_bf16 v[24:27], v[124:127], v[248:251], v[24:27]
    s_mul_i32 s64, s50, -960
    s_add_u32 s64, s64, 12480
    v_add_u32 v4, s64, v3
    v_mfma_f32_16x16x32_bf16 v[28:31], v[128:131], v[248:251], v[28:31]
    s_waitcnt lgkmcnt(1)
    s_add_u32 s65, s42, 81920
    buffer_load_dwordx4 v[224:227], v2, s[12:15], s65 offen offset:1024 sc1
    v_add_f32 v112, v112, v113
    v_mfma_f32_16x16x32_bf16 v[32:35], v[132:135], v[248:251], v[32:35]
    v_add_f32 v114, v114, v115
    v_add_f32 v116, v116, v117
    ds_read_b128 v[84:87], v9 offset:4096
    v_add_f32 v118, v118, v119
    v_add_f32 v120, v120, v121
    s_waitcnt lgkmcnt(11)
    v_add_f32 v122, v122, v123
    v_mul_f32 v114, s27, v114
    v_mul_f32 v118, s27, v118
    v_mfma_f32_16x16x32_bf16 v[36:39], v[124:127], v[252:255], v[36:39]
    v_mul_f32 v112, s27, v112
    s_add_u32 s65, s42, 122880
    buffer_load_dwordx4 v[228:231], v2, s[12:15], s65 offen offset:1024 sc1
    v_mul_f32 v120, s27, v120
    v_mfma_f32_16x16x32_bf16 v[40:43], v[128:131], v[252:255], v[40:43]
    v_fma_f32 v120, -v112, v112, v120
    v_max_f32 v120, 0, v120
    v_mfma_f32_16x16x32_bf16 v[44:47], v[132:135], v[252:255], v[44:47]
    v_add_f32 v120, s32, v120
    v_rsq_f32 v120, v120
    v_mul_f32 v116, s27, v116
    ds_read_b128 v[248:251], v8 offset:45056
    v_mul_f32 v122, s27, v122
    v_fma_f32 v122, -v116, v116, v122
    s_waitcnt lgkmcnt(9)
    v_max_f32 v122, 0, v122
    s_add_u32 s65, s42, 163840
    buffer_load_dwordx4 v[232:235], v2, s[12:15], s65 offen offset:1024 sc1
    v_add_f32 v122, s32, v122
    v_mfma_f32_16x16x32_bf16 v[48:51], v[124:127], v[60:63], v[48:51]
    v_rsq_f32 v122, v122
    s_mul_i32 s64, s48, 3072
    s_add_u32 s64, s64, 97280
    v_mfma_f32_16x16x32_bf16 v[52:55], v[128:131], v[60:63], v[52:55]
    v_add_u32 v3, s64, v2
    ds_write2_b32 v4, v120, v122 offset0:0 offset1:32
    v_mfma_f32_16x16x32_bf16 v[56:59], v[132:135], v[60:63], v[56:59]
    s_xor_b32 s64, s48, 4
    s_mul_i32 s64, s64, 3072
    ds_read_b128 v[252:255], v9 offset:45056
    s_add_u32 s65, s42, 204800
    buffer_load_dwordx4 v[236:239], v2, s[12:15], s65 offen offset:1024 sc1
    s_add_u32 s64, s64, 97280
    v_add_u32 v4, s64, v2
    ds_read_b128 v[124:127], v5 offset:0
    ds_read_b128 v[128:131], v5 offset:64
    ds_read_b128 v[132:135], v5 offset:128
    s_waitcnt lgkmcnt(7)
    v_mfma_f32_16x16x32_bf16 v[12:15], v[136:139], v[80:83], v[12:15]
    v_mfma_f32_16x16x32_bf16 v[16:19], v[140:143], v[80:83], v[16:19]
    v_mfma_f32_16x16x32_bf16 v[20:23], v[144:147], v[80:83], v[20:23]
    ds_read_b128 v[60:63], v8 offset:5120
    s_waitcnt lgkmcnt(7)
    v_mfma_f32_16x16x32_bf16 v[24:27], v[136:139], v[84:87], v[24:27]
    v_mfma_f32_16x16x32_bf16 v[28:31], v[140:143], v[84:87], v[28:31]
    buffer_load_dwordx4 v[240:243], v2, s[12:15], s42 offen offset:2048 sc1
    v_mfma_f32_16x16x32_bf16 v[32:35], v[144:147], v[84:87], v[32:35]
    ds_read_b128 v[80:83], v9 offset:5120
    s_waitcnt lgkmcnt(7)
    v_mfma_f32_16x16x32_bf16 v[36:39], v[136:139], v[248:251], v[36:39]
    s_waitcnt lgkmcnt(2)
    v_fma_f32 v12, -v124, v112, v12
    v_fma_f32 v13, -v125, v112, v13
    v_mfma_f32_16x16x32_bf16 v[40:43], v[140:143], v[248:251], v[40:43]
    v_fma_f32 v14, -v126, v112, v14
    v_fma_f32 v15, -v127, v112, v15
    s_setprio 2
    v_mfma_f32_16x16x32_bf16 v[44:47], v[144:147], v[248:251], v[44:47]
    v_fma_f32 v16, -v128, v112, v16
    v_fma_f32 v17, -v129, v112, v17
    s_add_u32 s65, s42, 40960
    buffer_load_dwordx4 v[244:247], v2, s[12:15], s65 offen offset:2048 sc1
    ds_read_b128 v[84:87], v8 offset:46080
    s_waitcnt lgkmcnt(6)
    v_mfma_f32_16x16x32_bf16 v[48:51], v[136:139], v[252:255], v[48:51]
    v_fma_f32 v24, -v124, v114, v24
    v_fma_f32 v25, -v125, v114, v25
    v_mfma_f32_16x16x32_bf16 v[52:55], v[140:143], v[252:255], v[52:55]
    v_fma_f32 v26, -v126, v114, v26
    v_fma_f32 v27, -v127, v114, v27
    v_mfma_f32_16x16x32_bf16 v[56:59], v[144:147], v[252:255], v[56:59]
    v_fma_f32 v28, -v128, v114, v28
    v_fma_f32 v29, -v129, v114, v29
    ds_read_b128 v[248:251], v9 offset:46080
    s_waitcnt lgkmcnt(3)
    s_add_u32 s65, s42, 81920
    buffer_load_dwordx4 v[136:139], v2, s[12:15], s65 offen offset:3072 sc1
    v_mfma_f32_16x16x32_bf16 v[12:15], v[148:151], v[60:63], v[12:15]
    v_mfma_f32_16x16x32_bf16 v[16:19], v[152:155], v[60:63], v[16:19]
    v_mfma_f32_16x16x32_bf16 v[20:23], v[156:159], v[60:63], v[20:23]
    ds_read_b128 v[252:255], v8 offset:6144
    s_waitcnt lgkmcnt(3)
    v_mfma_f32_16x16x32_bf16 v[24:27], v[148:151], v[80:83], v[24:27]
    v_mfma_f32_16x16x32_bf16 v[28:31], v[152:155], v[80:83], v[28:31]
    v_mfma_f32_16x16x32_bf16 v[32:35], v[156:159], v[80:83], v[32:35]
    ds_read_b128 v[60:63], v9 offset:6144
    s_waitcnt lgkmcnt(3)
    s_add_u32 s65, s42, 122880
    buffer_load_dwordx4 v[140:143], v2, s[12:15], s65 offen offset:3072 sc1
    v_mfma_f32_16x16x32_bf16 v[36:39], v[148:151], v[84:87], v[36:39]
    v_fma_f32 v18, -v130, v112, v18
    v_fma_f32 v19, -v131, v112, v19
    v_mfma_f32_16x16x32_bf16 v[40:43], v[152:155], v[84:87], v[40:43]
    v_fma_f32 v20, -v132, v112, v20
    v_fma_f32 v21, -v133, v112, v21
    v_mfma_f32_16x16x32_bf16 v[44:47], v[156:159], v[84:87], v[44:47]
    v_fma_f32 v22, -v134, v112, v22
    v_fma_f32 v23, -v135, v112, v23
    ds_read_b128 v[80:83], v8 offset:7168
    s_waitcnt lgkmcnt(3)
    s_add_u32 s65, s42, 163840
    buffer_load_dwordx4 v[144:147], v2, s[12:15], s65 offen offset:3072 sc1
    v_mfma_f32_16x16x32_bf16 v[48:51], v[148:151], v[248:251], v[48:51]
    v_fma_f32 v30, -v130, v114, v30
    v_fma_f32 v31, -v131, v114, v31
    v_mfma_f32_16x16x32_bf16 v[52:55], v[152:155], v[248:251], v[52:55]
    v_fma_f32 v32, -v132, v114, v32
    v_fma_f32 v33, -v133, v114, v33
    s_setprio 1
    v_mfma_f32_16x16x32_bf16 v[56:59], v[156:159], v[248:251], v[56:59]
    v_fma_f32 v34, -v134, v114, v34
    v_fma_f32 v35, -v135, v114, v35
    ds_read_b128 v[84:87], v9 offset:7168
    s_waitcnt lgkmcnt(3)
    s_add_u32 s65, s42, 204800
    buffer_load_dwordx4 v[148:151], v2, s[12:15], s65 offen offset:3072 sc1
    v_mfma_f32_16x16x32_bf16 v[12:15], v[160:163], v[252:255], v[12:15]
    v_mfma_f32_16x16x32_bf16 v[16:19], v[164:167], v[252:255], v[16:19]
    v_mfma_f32_16x16x32_bf16 v[20:23], v[168:171], v[252:255], v[20:23]
    ds_read_b128 v[248:251], v8 offset:8192
    s_waitcnt lgkmcnt(3)
    v_mfma_f32_16x16x32_bf16 v[24:27], v[160:163], v[60:63], v[24:27]
    v_mfma_f32_16x16x32_bf16 v[28:31], v[164:167], v[60:63], v[28:31]
    v_mfma_f32_16x16x32_bf16 v[32:35], v[168:171], v[60:63], v[32:35]
    ds_read_b128 v[252:255], v9 offset:8192
    s_waitcnt lgkmcnt(3)
    s_add_u32 s65, s42, 4096
    buffer_load_dwordx4 v[152:155], v2, s[12:15], s65 offen offset:0 sc1
    v_mfma_f32_16x16x32_bf16 v[12:15], v[172:175], v[80:83], v[12:15]
    v_mfma_f32_16x16x32_bf16 v[16:19], v[176:179], v[80:83], v[16:19]
    v_mfma_f32_16x16x32_bf16 v[20:23], v[180:183], v[80:83], v[20:23]
    ds_read_b128 v[60:63], v8 offset:9216
    s_waitcnt lgkmcnt(3)
    v_mfma_f32_16x16x32_bf16 v[24:27], v[172:175], v[84:87], v[24:27]
    v_mfma_f32_16x16x32_bf16 v[28:31], v[176:179], v[84:87], v[28:31]
    v_mfma_f32_16x16x32_bf16 v[32:35], v[180:183], v[84:87], v[32:35]
    ds_read_b128 v[80:83], v9 offset:9216
    s_waitcnt lgkmcnt(3)
    s_add_u32 s65, s42, 45056
    buffer_load_dwordx4 v[156:159], v2, s[12:15], s65 offen offset:0 sc1
    v_mfma_f32_16x16x32_bf16 v[12:15], v[184:187], v[248:251], v[12:15]
    v_mfma_f32_16x16x32_bf16 v[16:19], v[188:191], v[248:251], v[16:19]
    v_mfma_f32_16x16x32_bf16 v[20:23], v[192:195], v[248:251], v[20:23]
    ds_read_b128 v[84:87], v8 offset:47104
    s_waitcnt lgkmcnt(3)
    v_mfma_f32_16x16x32_bf16 v[24:27], v[184:187], v[252:255], v[24:27]
    v_mfma_f32_16x16x32_bf16 v[28:31], v[188:191], v[252:255], v[28:31]
    v_mfma_f32_16x16x32_bf16 v[32:35], v[192:195], v[252:255], v[32:35]
    ds_read_b128 v[248:251], v9 offset:47104
    s_waitcnt lgkmcnt(3)
    v_mfma_f32_16x16x32_bf16 v[12:15], v[196:199], v[60:63], v[12:15]
    v_mfma_f32_16x16x32_bf16 v[16:19], v[200:203], v[60:63], v[16:19]
    v_mfma_f32_16x16x32_bf16 v[20:23], v[204:207], v[60:63], v[20:23]
    ds_read_b128 v[252:255], v8 offset:48128
    s_waitcnt lgkmcnt(3)
    v_mfma_f32_16x16x32_bf16 v[24:27], v[196:199], v[80:83], v[24:27]
    v_mfma_f32_16x16x32_bf16 v[28:31], v[200:203], v[80:83], v[28:31]
    v_mfma_f32_16x16x32_bf16 v[32:35], v[204:207], v[80:83], v[32:35]
    ds_read_b128 v[60:63], v9 offset:48128
    s_mul_i32 s64, s50, 6144
    s_sub_u32 s16, s25, s64
    s_add_u32 s25, s25, s64
    s_setprio 0
    s_waitcnt lgkmcnt(3)
    v_mfma_f32_16x16x32_bf16 v[36:39], v[160:163], v[84:87], v[36:39]
    v_mfma_f32_16x16x32_bf16 v[40:43], v[164:167], v[84:87], v[40:43]
    v_mfma_f32_16x16x32_bf16 v[44:47], v[168:171], v[84:87], v[44:47]
    ds_write_b128 v3, v[24:27] offset:0
    ds_read_b128 v[80:83], v8 offset:49152
    s_waitcnt lgkmcnt(4)
    ds_write_b128 v3, v[28:31] offset:1024
    v_mfma_f32_16x16x32_bf16 v[48:51], v[160:163], v[248:251], v[48:51]
    v_mfma_f32_16x16x32_bf16 v[52:55], v[164:167], v[248:251], v[52:55]
    ds_write_b128 v3, v[32:35] offset:2048
    v_mfma_f32_16x16x32_bf16 v[56:59], v[168:171], v[248:251], v[56:59]
    ds_read_b128 v[84:87], v9 offset:49152
    s_waitcnt lgkmcnt(1)
    s_barrier
    ds_read_b128 v[24:27], v4 offset:0
    ds_read_b128 v[28:31], v4 offset:1024
    ds_read_b128 v[32:35], v4 offset:2048
    s_setprio 2
    s_waitcnt lgkmcnt(9)
    v_mfma_f32_16x16x32_bf16 v[36:39], v[172:175], v[252:255], v[36:39]
    s_waitcnt lgkmcnt(2)
    v_mfma_f32_16x16x32_bf16 v[40:43], v[176:179], v[252:255], v[40:43]
    v_add_f32 v12, v12, v24
    v_add_f32 v13, v13, v25
    v_add_f32 v14, v14, v26
    v_add_f32 v15, v15, v27
    v_mfma_f32_16x16x32_bf16 v[44:47], v[180:183], v[252:255], v[44:47]
    v_cvt_pk_bf16_f32 v12, v12, v13
    v_cvt_pk_bf16_f32 v13, v14, v15
    v_pk_max_i16 v12, v12, 0
    ds_read_b128 v[248:251], v8 offset:50176
    v_pk_max_i16 v13, v13, 0
    s_waitcnt lgkmcnt(2)
    v_add_f32 v16, v16, v28
    s_waitcnt lgkmcnt(9)
    v_add_f32 v17, v17, v29
    v_add_f32 v18, v18, v30
    v_add_f32 v19, v19, v31
    v_cvt_pk_bf16_f32 v14, v16, v17
    v_mfma_f32_16x16x32_bf16 v[48:51], v[172:175], v[60:63], v[48:51]
    v_cvt_pk_bf16_f32 v15, v18, v19
    v_pk_max_i16 v14, v14, 0
    v_pk_max_i16 v15, v15, 0
    v_mfma_f32_16x16x32_bf16 v[52:55], v[176:179], v[60:63], v[52:55]
    s_waitcnt lgkmcnt(1)
    v_add_f32 v20, v20, v32
    v_add_f32 v21, v21, v33
    v_add_f32 v22, v22, v34
    v_mfma_f32_16x16x32_bf16 v[56:59], v[180:183], v[60:63], v[56:59]
    v_add_f32 v23, v23, v35
    v_cvt_pk_bf16_f32 v16, v20, v21
    v_cvt_pk_bf16_f32 v17, v22, v23
    ds_read_b128 v[252:255], v9 offset:50176
    v_pk_max_i16 v16, v16, 0
    v_pk_max_i16 v17, v17, 0
    s_cmp_eq_u32 s63, 0
    s_cbranch_scc1 L_ps_49
    buffer_store_dwordx4 v[12:15], v2, s[12:15], s19 offen
    buffer_store_dwordx2 v[16:17], v2, s[12:15], s24 offen
L_pj_50:
    s_setprio 0
    s_waitcnt lgkmcnt(8)
    s_waitcnt vmcnt(22)
    v_mfma_f32_16x16x32_bf16 v[36:39], v[184:187], v[80:83], v[36:39]
    ds_read_b128 v[160:163], v3 offset:25600
    v_mfma_f32_16x16x32_bf16 v[40:43], v[188:191], v[80:83], v[40:43]
    ds_read_b128 v[164:167], v3 offset:26624
    v_mfma_f32_16x16x32_bf16 v[44:47], v[192:195], v[80:83], v[44:47]
    ds_read_b128 v[168:171], v3 offset:27648
    s_waitcnt lgkmcnt(8)
    s_add_u32 s65, s42, 208896
    buffer_load_dwordx4 v[172:175], v2, s[12:15], s65 offen offset:0 sc1
    v_mfma_f32_16x16x32_bf16 v[48:51], v[184:187], v[84:87], v[48:51]
    s_waitcnt vmcnt(1)
    v_mfma_f32_16x16x32_bf16 v[52:55], v[188:191], v[84:87], v[52:55]
    buffer_load_dwordx4 v[12:15], v2, s[12:15], s25 offen offset:0 sc1
    v_mfma_f32_16x16x32_bf16 v[56:59], v[192:195], v[84:87], v[56:59]
    s_waitcnt lgkmcnt(4)
    v_mfma_f32_16x16x32_bf16 v[36:39], v[196:199], v[248:251], v[36:39]
    v_mfma_f32_16x16x32_bf16 v[40:43], v[200:203], v[248:251], v[40:43]
    v_mfma_f32_16x16x32_bf16 v[44:47], v[204:207], v[248:251], v[44:47]
    s_waitcnt lgkmcnt(3)
    buffer_load_dwordx4 v[16:19], v2, s[12:15], s25 offen offset:1024 sc1
    v_mfma_f32_16x16x32_bf16 v[48:51], v[196:199], v[252:255], v[48:51]
    v_mfma_f32_16x16x32_bf16 v[52:55], v[200:203], v[252:255], v[52:55]
    v_mfma_f32_16x16x32_bf16 v[56:59], v[204:207], v[252:255], v[56:59]
    s_nop 0
    v_fma_f32 v36, -v124, v116, v36
    v_fma_f32 v37, -v125, v116, v37
    v_fma_f32 v38, -v126, v116, v38
    buffer_load_dwordx4 v[20:23], v2, s[12:15], s25 offen offset:2048 sc1
    v_fma_f32 v39, -v127, v116, v39
    v_fma_f32 v40, -v128, v116, v40
    v_fma_f32 v41, -v129, v116, v41
    v_fma_f32 v42, -v130, v116, v42
    v_fma_f32 v43, -v131, v116, v43
    v_fma_f32 v44, -v132, v116, v44
    buffer_load_dwordx4 v[24:27], v2, s[12:15], s25 offen offset:3072 sc1
    v_fma_f32 v45, -v133, v116, v45
    v_fma_f32 v46, -v134, v116, v46
    v_fma_f32 v47, -v135, v116, v47
    v_fma_f32 v48, -v124, v118, v48
    v_fma_f32 v49, -v125, v118, v49
    v_fma_f32 v50, -v126, v118, v50
    s_add_u32 s65, s25, 4096
    buffer_load_dwordx4 v[28:31], v2, s[12:15], s65 offen offset:0 sc1
    v_fma_f32 v51, -v127, v118, v51
    v_fma_f32 v52, -v128, v118, v52
    v_fma_f32 v53, -v129, v118, v53
    v_fma_f32 v54, -v130, v118, v54
    v_fma_f32 v55, -v131, v118, v55
    v_fma_f32 v56, -v132, v118, v56
    s_add_u32 s65, s25, 4096
    buffer_load_dwordx4 v[32:35], v2, s[12:15], s65 offen offset:1024 sc1
    v_fma_f32 v57, -v133, v118, v57
    v_fma_f32 v58, -v134, v118, v58
    v_fma_f32 v59, -v135, v118, v59
    ds_write_b128 v3, v[48:51] offset:25600
    ds_write_b128 v3, v[52:55] offset:26624
    ds_write_b128 v3, v[56:59] offset:27648
    s_waitcnt lgkmcnt(0)
    s_barrier
    ds_read_b128 v[48:51], v4 offset:25600
    ds_read_b128 v[52:55], v4 offset:26624
    ds_read_b128 v[56:59], v4 offset:27648
    s_waitcnt lgkmcnt(2)
    v_add_f32 v36, v36, v48
    v_add_f32 v37, v37, v49
    v_add_f32 v38, v38, v50
    v_add_f32 v39, v39, v51
    v_cvt_pk_bf16_f32 v36, v36, v37
    v_cvt_pk_bf16_f32 v37, v38, v39
    v_pk_max_i16 v36, v36, 0
    v_pk_max_i16 v37, v37, 0
    s_waitcnt lgkmcnt(1)
    v_add_f32 v40, v40, v52
    v_add_f32 v41, v41, v53
    v_add_f32 v42, v42, v54
    v_add_f32 v43, v43, v55
    v_cvt_pk_bf16_f32 v38, v40, v41
    v_cvt_pk_bf16_f32 v39, v42, v43
    v_pk_max_i16 v38, v38, 0
    v_pk_max_i16 v39, v39, 0
    s_waitcnt lgkmcnt(0)
    v_add_f32 v44, v44, v56
    v_add_f32 v45, v45, v57
    v_add_f32 v46, v46, v58
    v_add_f32 v47, v47, v59
    v_cvt_pk_bf16_f32 v40, v44, v45
    v_cvt_pk_bf16_f32 v41, v46, v47
    v_pk_max_i16 v40, v40, 0
    v_pk_max_i16 v41, v41, 0
    s_add_u32 s19, s19, 12288
    s_add_u32 s24, s24, 12288
    s_cmp_eq_u32 s63, 0
    s_cbranch_scc1 L_ps_51
    buffer_store_dwordx4 v[36:39], v2, s[12:15], s19 offen
    buffer_store_dwordx2 v[40:41], v2, s[12:15], s24 offen
L_pj_52:
    v_and_b32 v7, 15, v1
    s_add_u32 s65, s16, 4096
    buffer_load_dwordx4 v[112:115], v2, s[12:15], s65 offen offset:2048 sc1
    v_mul_u32_u24 v7, 336, v7
    v_and_b32 v11, 48, v1
    s_xor_b32 s66, s48, 4
    s_mul_i32 s67, s66, 5376
    s_add_u32 s67, s67, 40960
    v_add3_u32 v7, v7, v11, s67
    s_mul_i32 s67, s48, 672
    s_add_u32 s67, s67, 40960
    v_add_u32 v6, s67, v2
    s_mul_i32 s67, s48, 5120
    s_add_u32 s65, s16, 4096
    buffer_load_dwordx4 v[116:119], v2, s[12:15], s65 offen offset:3072 sc1
    v_add_u32 v8, s67, v2
    s_mul_i32 s67, s66, 5120
    v_add_u32 v9, s67, v2
    s_mul_i32 s67, s48, 336
    s_add_u32 s67, s67, 86016
    v_lshl_add_u32 v10, v1, 3, s67
    v_mul_u32_u24 v11, 49, v1
    v_lshrrev_b32 v11, 10, v11
    v_mul_u32_u24 v5, 1112, v11
    v_lshl_add_u32 v5, v1, 3, v5
    s_add_u32 s65, s16, 8192
    buffer_load_dwordx4 v[120:123], v2, s[12:15], s65 offen offset:0 sc1
    s_mul_i32 s67, s48, 2560
    s_add_u32 s26, s26, s67
    s_mov_b32 s34, 0xffefffff
    s_movk_i32 s35, 0x1ff
    s_lshl_b32 s67, s48, 3
    s_add_u32 s67, s67, 160000
    v_lshl_add_u32 v0, v11, 2, s67
    v_add_u32 v3, 56320, v7
    v_add_u32 v4, 56320, v6
    s_waitcnt vmcnt(5)
    v_max3_u32 v11, v12, v16, v20
    v_max3_u32 v11, v11, v24, v28
    v_max3_u32 v11, v11, v30, v32
    v_max_u32 v11, v11, v34
    v_cmp_eq_u32 vcc, -1, v11
    s_cbranch_vccnz L_g0
L_g0_x:
    s_setprio 1
    v_mfma_f32_16x16x32_bf16 v[60:63], v[64:67], v[12:15], 0
    s_add_u32 s65, s16, 8192
    buffer_load_dwordx4 v[124:127], v2, s[12:15], s65 offen offset:1024 sc1
    v_mfma_f32_16x16x32_bf16 v[60:63], v[68:71], v[16:19], v[60:63]
    v_mfma_f32_16x16x32_bf16 v[60:63], v[72:75], v[20:23], v[60:63]
    v_mfma_f32_16x16x32_bf16 v[60:63], v[76:79], v[24:27], v[60:63]
    v_mfma_f32_16x16x32_bf16 v[60:63], v[208:211], v[28:31], v[60:63]
    v_mfma_f32_16x16x32_bf16 v[60:63], v[212:215], v[32:35], v[60:63]
    v_mfma_f32_16x16x32_bf16 v[80:83], v[216:219], v[12:15], 0
    s_setprio 0
    s_add_u32 s65, s16, 8192
    buffer_load_dwordx4 v[128:131], v2, s[12:15], s65 offen offset:2048 sc1
    v_mfma_f32_16x16x32_bf16 v[80:83], v[220:223], v[16:19], v[80:83]
    v_mfma_f32_16x16x32_bf16 v[80:83], v[224:227], v[20:23], v[80:83]
    v_mfma_f32_16x16x32_bf16 v[80:83], v[228:231], v[24:27], v[80:83]
    v_mfma_f32_16x16x32_bf16 v[80:83], v[232:235], v[28:31], v[80:83]
    ds_write_b128 v8, v[60:63] offset:0
    v_mfma_f32_16x16x32_bf16 v[80:83], v[236:239], v[32:35], v[80:83]
    s_setprio 2
    s_add_u32 s65, s16, 8192
    buffer_load_dwordx4 v[132:135], v2, s[12:15], s65 offen offset:3072 sc1
    v_mfma_f32_16x16x32_bf16 v[84:87], v[240:243], v[12:15], 0
    v_mfma_f32_16x16x32_bf16 v[84:87], v[244:247], v[16:19], v[84:87]
    v_mfma_f32_16x16x32_bf16 v[84:87], v[88:91], v[20:23], v[84:87]
    v_mfma_f32_16x16x32_bf16 v[84:87], v[92:95], v[24:27], v[84:87]
    v_mfma_f32_16x16x32_bf16 v[84:87], v[96:99], v[28:31], v[84:87]
    ds_write_b128 v8, v[80:83] offset:1024
    v_mfma_f32_16x16x32_bf16 v[84:87], v[100:103], v[32:35], v[84:87]
    s_add_u32 s65, s25, 12288
    buffer_load_dwordx4 v[176:179], v2, s[12:15], s65 offen offset:0 sc1
    v_mfma_f32_16x16x32_bf16 v[248:251], v[104:107], v[12:15], 0
    v_mfma_f32_16x16x32_bf16 v[248:251], v[108:111], v[16:19], v[248:251]
    s_setprio 1
    v_mfma_f32_16x16x32_bf16 v[248:251], v[136:139], v[20:23], v[248:251]
    v_mfma_f32_16x16x32_bf16 v[248:251], v[140:143], v[24:27], v[248:251]
    v_mfma_f32_16x16x32_bf16 v[248:251], v[144:147], v[28:31], v[248:251]
    ds_write_b128 v8, v[84:87] offset:2048
    s_add_u32 s65, s25, 12288
    buffer_load_dwordx4 v[180:183], v2, s[12:15], s65 offen offset:1024 sc1
    v_mfma_f32_16x16x32_bf16 v[248:251], v[148:151], v[32:35], v[248:251]
    v_mfma_f32_16x16x32_bf16 v[252:255], v[152:155], v[12:15], 0
    s_setprio 0
    v_mfma_f32_16x16x32_bf16 v[252:255], v[156:159], v[16:19], v[252:255]
    s_waitcnt lgkmcnt(0)
    s_barrier
    ds_read_b128 v[60:63], v9 offset:0
    ds_read_b128 v[80:83], v9 offset:1024
    s_add_u32 s65, s25, 12288
    buffer_load_dwordx4 v[184:187], v2, s[12:15], s65 offen offset:2048 sc1
    ds_read_b128 v[84:87], v9 offset:2048
    v_mfma_f32_16x16x32_bf16 v[252:255], v[160:163], v[20:23], v[252:255]
    v_mfma_f32_16x16x32_bf16 v[252:255], v[164:167], v[24:27], v[252:255]
    v_mfma_f32_16x16x32_bf16 v[252:255], v[168:171], v[28:31], v[252:255]
    ds_write_b128 v8, v[248:251] offset:3072
    v_mfma_f32_16x16x32_bf16 v[252:255], v[172:175], v[32:35], v[252:255]
    s_waitcnt vmcnt(3)
    v_max3_u32 v11, v112, v116, v120
    v_max3_u32 v11, v11, v124, v128
    v_max3_u32 v11, v11, v130, v132
    v_max_u32 v11, v11, v134
    v_cmp_eq_u32 vcc, -1, v11
    s_cbranch_vccnz L_g1
L_g1_x:
    s_setprio 1
    s_waitcnt lgkmcnt(3)
    s_add_u32 s65, s25, 12288
    buffer_load_dwordx4 v[188:191], v2, s[12:15], s65 offen offset:3072 sc1
    v_mfma_f32_16x16x32_bf16 v[60:63], v[64:67], v[112:115], v[60:63]
    v_mfma_f32_16x16x32_bf16 v[60:63], v[68:71], v[116:119], v[60:63]
    v_mfma_f32_16x16x32_bf16 v[60:63], v[72:75], v[120:123], v[60:63]
    v_mfma_f32_16x16x32_bf16 v[60:63], v[76:79], v[124:127], v[60:63]
    v_mfma_f32_16x16x32_bf16 v[60:63], v[208:211], v[128:131], v[60:63]
    ds_write_b128 v8, v[252:255] offset:4096
    s_add_u32 s65, s25, 16384
    buffer_load_dwordx4 v[192:195], v2, s[12:15], s65 offen offset:0 sc1
    v_mfma_f32_16x16x32_bf16 v[60:63], v[212:215], v[132:135], v[60:63]
    s_waitcnt lgkmcnt(3)
    s_setprio 0
    v_mfma_f32_16x16x32_bf16 v[80:83], v[216:219], v[112:115], v[80:83]
    v_mfma_f32_16x16x32_bf16 v[80:83], v[220:223], v[116:119], v[80:83]
    v_mfma_f32_16x16x32_bf16 v[80:83], v[224:227], v[120:123], v[80:83]
    v_mfma_f32_16x16x32_bf16 v[80:83], v[228:231], v[124:127], v[80:83]
    s_add_u32 s65, s25, 16384
    buffer_load_dwordx4 v[196:199], v2, s[12:15], s65 offen offset:1024 sc1
    s_waitcnt lgkmcnt(0)
    s_barrier
    ds_read_b128 v[248:251], v9 offset:3072
    ds_read_b128 v[252:255], v9 offset:4096
    v_mfma_f32_16x16x32_bf16 v[80:83], v[232:235], v[128:131], v[80:83]
    s_setprio 2
    ds_write_b128 v7, v[60:63] offset:0
    v_mfma_f32_16x16x32_bf16 v[80:83], v[236:239], v[132:135], v[80:83]
    s_add_u32 s65, s16, 16384
    buffer_load_dwordx4 v[36:39], v2, s[12:15], s65 offen offset:2048 sc1
    s_waitcnt lgkmcnt(5)
    v_mfma_f32_16x16x32_bf16 v[84:87], v[240:243], v[112:115], v[84:87]
    v_mfma_f32_16x16x32_bf16 v[84:87], v[244:247], v[116:119], v[84:87]
    v_mfma_f32_16x16x32_bf16 v[84:87], v[88:91], v[120:123], v[84:87]
    v_mfma_f32_16x16x32_bf16 v[84:87], v[92:95], v[124:127], v[84:87]
    v_mfma_f32_16x16x32_bf16 v[84:87], v[96:99], v[128:131], v[84:87]
    ds_write_b128 v7, v[80:83] offset:64
    s_add_u32 s65, s16, 16384
    buffer_load_dwordx4 v[40:43], v2, s[12:15], s65 offen offset:3072 sc1
    v_mfma_f32_16x16x32_bf16 v[84:87], v[100:103], v[132:135], v[84:87]
    s_waitcnt lgkmcnt(3)
    v_mfma_f32_16x16x32_bf16 v[248:251], v[104:107], v[112:115], v[248:251]
    s_setprio 1
    v_mfma_f32_16x16x32_bf16 v[248:251], v[108:111], v[116:119], v[248:251]
    v_mfma_f32_16x16x32_bf16 v[248:251], v[136:139], v[120:123], v[248:251]
    v_mfma_f32_16x16x32_bf16 v[248:251], v[140:143], v[124:127], v[248:251]
    s_add_u32 s65, s16, 20480
    buffer_load_dwordx4 v[44:47], v2, s[12:15], s65 offen offset:0 sc1
    v_mfma_f32_16x16x32_bf16 v[248:251], v[144:147], v[128:131], v[248:251]
    ds_write_b128 v7, v[84:87] offset:128
    v_mfma_f32_16x16x32_bf16 v[248:251], v[148:151], v[132:135], v[248:251]
    s_waitcnt lgkmcnt(3)
    v_mfma_f32_16x16x32_bf16 v[252:255], v[152:155], v[112:115], v[252:255]
    s_setprio 0
    s_waitcnt vmcnt(3)
    s_add_u32 s65, s16, 20480
    buffer_load_dwordx4 v[48:51], v2, s[12:15], s65 offen offset:1024 sc1
    v_mfma_f32_16x16x32_bf16 v[252:255], v[156:159], v[116:119], v[252:255]
    v_max3_u32 v11, v176, v180, v184
    v_mfma_f32_16x16x32_bf16 v[252:255], v[160:163], v[120:123], v[252:255]
    v_max3_u32 v11, v11, v188, v192
    v_mfma_f32_16x16x32_bf16 v[252:255], v[164:167], v[124:127], v[252:255]
    v_max3_u32 v11, v11, v194, v196
    s_add_u32 s65, s16, 20480
    buffer_load_dwordx4 v[52:55], v2, s[12:15], s65 offen offset:2048 sc1
    v_mfma_f32_16x16x32_bf16 v[252:255], v[168:171], v[128:131], v[252:255]
    v_max_u32 v11, v11, v198
    ds_write_b128 v7, v[248:251] offset:192
    v_cmp_eq_u32 vcc, -1, v11
    v_mfma_f32_16x16x32_bf16 v[252:255], v[172:175], v[132:135], v[252:255]
    s_cbranch_vccnz L_g2
L_g2_x:
    s_setprio 1
    v_mfma_f32_16x16x32_bf16 v[60:63], v[64:67], v[176:179], 0
    s_add_u32 s65, s16, 20480
    buffer_load_dwordx4 v[56:59], v2, s[12:15], s65 offen offset:3072 sc1
    v_mfma_f32_16x16x32_bf16 v[60:63], v[68:71], v[180:183], v[60:63]
    v_mfma_f32_16x16x32_bf16 v[60:63], v[72:75], v[184:187], v[60:63]
    v_mfma_f32_16x16x32_bf16 v[60:63], v[76:79], v[188:191], v[60:63]
    v_mfma_f32_16x16x32_bf16 v[60:63], v[208:211], v[192:195], v[60:63]
    ds_write_b128 v7, v[252:255] offset:256
    v_mfma_f32_16x16x32_bf16 v[60:63], v[212:215], v[196:199], v[60:63]
    v_mfma_f32_16x16x32_bf16 v[80:83], v[216:219], v[176:179], 0
    v_mfma_f32_16x16x32_bf16 v[80:83], v[220:223], v[180:183], v[80:83]
    v_mfma_f32_16x16x32_bf16 v[80:83], v[224:227], v[184:187], v[80:83]
    v_mfma_f32_16x16x32_bf16 v[80:83], v[228:231], v[188:191], v[80:83]
    s_waitcnt lgkmcnt(0)
    s_barrier
    v_mfma_f32_16x16x32_bf16 v[80:83], v[232:235], v[192:195], v[80:83]
    s_setprio 0
    ds_read_b64 v[32:33], v10 offset:0
    ds_read_b32 v34, v0 offset:0
    ds_write_b128 v8, v[60:63] offset:0
    ds_read_b128 v[12:15], v6 offset:0
    v_mfma_f32_16x16x32_bf16 v[80:83], v[236:239], v[196:199], v[80:83]
    ds_read_b128 v[16:19], v6 offset:5376
    v_mfma_f32_16x16x32_bf16 v[84:87], v[240:243], v[176:179], 0
    ds_read_b128 v[20:23], v6 offset:10752
    v_mfma_f32_16x16x32_bf16 v[84:87], v[244:247], v[180:183], v[84:87]
    ds_read_b128 v[24:27], v6 offset:16128
    v_mfma_f32_16x16x32_bf16 v[84:87], v[88:91], v[184:187], v[84:87]
    s_setprio 2
    v_mfma_f32_16x16x32_bf16 v[84:87], v[92:95], v[188:191], v[84:87]
    v_mfma_f32_16x16x32_bf16 v[84:87], v[96:99], v[192:195], v[84:87]
    ds_write_b128 v8, v[80:83] offset:1024
    s_waitcnt lgkmcnt(6)
    v_mfma_f32_16x16x32_bf16 v[84:87], v[100:103], v[196:199], v[84:87]
    v_lshlrev_b32 v28, 16, v32
    v_mfma_f32_16x16x32_bf16 v[248:251], v[104:107], v[176:179], 0
    v_and_b32 v29, 0xffff0000, v32
    v_mfma_f32_16x16x32_bf16 v[248:251], v[108:111], v[180:183], v[248:251]
    v_lshlrev_b32 v30, 16, v33
    v_mfma_f32_16x16x32_bf16 v[248:251], v[136:139], v[184:187], v[248:251]
    v_and_b32 v31, 0xffff0000, v33
    v_mfma_f32_16x16x32_bf16 v[248:251], v[140:143], v[188:191], v[248:251]
    s_waitcnt lgkmcnt(1)
    s_setprio 1
    v_mfma_f32_16x16x32_bf16 v[248:251], v[144:147], v[192:195], v[248:251]
    v_add_f32 v12, v12, v16
    ds_write_b128 v8, v[84:87] offset:2048
    v_add_f32 v13, v13, v17
    v_mfma_f32_16x16x32_bf16 v[248:251], v[148:151], v[196:199], v[248:251]
    v_add_f32 v14, v14, v18
    v_mfma_f32_16x16x32_bf16 v[252:255], v[152:155], v[176:179], 0
    v_add_f32 v15, v15, v19
    v_mfma_f32_16x16x32_bf16 v[252:255], v[156:159], v[180:183], v[252:255]
    v_add_f32 v20, v20, v24
    s_setprio 0
    s_waitcnt lgkmcnt(0)
    s_barrier
    v_add_f32 v21, v21, v25
    ds_read_b128 v[60:63], v9 offset:0
    v_add_f32 v22, v22, v26
    ds_read_b128 v[80:83], v9 offset:1024
    s_waitcnt vmcnt(0)
    ds_read_b128 v[84:87], v9 offset:2048
    v_max3_u32 v11, v36, v40, v44
    v_mfma_f32_16x16x32_bf16 v[252:255], v[160:163], v[184:187], v[252:255]
    v_max3_u32 v11, v11, v48, v52
    v_mfma_f32_16x16x32_bf16 v[252:255], v[164:167], v[188:191], v[252:255]
    v_max3_u32 v11, v11, v54, v56
    v_mfma_f32_16x16x32_bf16 v[252:255], v[168:171], v[192:195], v[252:255]
    v_max_u32 v11, v11, v58
    ds_write_b128 v8, v[248:251] offset:3072
    v_cmp_eq_u32 vcc, -1, v11
    v_mfma_f32_16x16x32_bf16 v[252:255], v[172:175], v[196:199], v[252:255]
    s_cbranch_vccnz L_g3
L_g3_x:
    s_lshr_b32 s66, s2, 3
    s_and_b32 s66, s66, 31
    s_xor_b32 s67, s48, 7
    s_or_b32 s66, s66, s67
    s_cbranch_scc1 L_wb_53
    buffer_wbl2 sc1
L_wb_53:
    s_setprio 1
    s_waitcnt lgkmcnt(3)
    v_mfma_f32_16x16x32_bf16 v[60:63], v[64:67], v[36:39], v[60:63]
    v_mfma_f32_16x16x32_bf16 v[60:63], v[68:71], v[40:43], v[60:63]
    v_add_f32 v23, v23, v27
    v_add_f32 v12, v12, v20
    v_mfma_f32_16x16x32_bf16 v[60:63], v[72:75], v[44:47], v[60:63]
    v_add_f32 v13, v13, v21
    v_mfma_f32_16x16x32_bf16 v[60:63], v[76:79], v[48:51], v[60:63]
    v_add_f32 v14, v14, v22
    v_mfma_f32_16x16x32_bf16 v[60:63], v[208:211], v[52:55], v[60:63]
    v_add_f32 v15, v15, v23
    ds_write_b128 v8, v[252:255] offset:4096
    v_fmac_f32 v28, v34, v12
    v_fmac_f32 v29, v34, v13
    v_mfma_f32_16x16x32_bf16 v[60:63], v[212:215], v[56:59], v[60:63]
    v_fmac_f32 v30, v34, v14
    s_waitcnt lgkmcnt(3)
    s_setprio 0
    v_fmac_f32 v31, v34, v15
    v_mfma_f32_16x16x32_bf16 v[80:83], v[216:219], v[36:39], v[80:83]
    v_cvt_pk_bf16_f32 v12, v28, v29
    v_mfma_f32_16x16x32_bf16 v[80:83], v[220:223], v[40:43], v[80:83]
    v_cvt_pk_bf16_f32 v13, v30, v31
    v_mfma_f32_16x16x32_bf16 v[80:83], v[224:227], v[44:47], v[80:83]
    s_add_u32 s66, s26, 0
    s_mov_b64 exec, s[34:35]
    buffer_store_dwordx2 v[12:13], v5, s[44:47], s66 offen
    s_mov_b64 exec, -1
    ds_read_b64 v[132:133], v10 offset:2688
    v_mfma_f32_16x16x32_bf16 v[80:83], v[228:231], v[48:51], v[80:83]
    ds_read_b32 v134, v0 offset:64
    s_waitcnt lgkmcnt(2)
    s_barrier
    ds_read_b128 v[112:115], v6 offset:21504
    ds_read_b128 v[248:251], v9 offset:3072
    ds_read_b128 v[116:119], v6 offset:26880
    ds_read_b128 v[252:255], v9 offset:4096
    s_setprio 2
    ds_read_b128 v[120:123], v6 offset:32256
    v_mfma_f32_16x16x32_bf16 v[80:83], v[232:235], v[52:55], v[80:83]
    ds_read_b128 v[124:127], v6 offset:37632
    ds_write_b128 v3, v[60:63] offset:0
    v_mfma_f32_16x16x32_bf16 v[80:83], v[236:239], v[56:59], v[80:83]
    s_waitcnt lgkmcnt(11)
    s_waitcnt lgkmcnt(7)
    v_mfma_f32_16x16x32_bf16 v[84:87], v[240:243], v[36:39], v[84:87]
    v_lshlrev_b32 v128, 16, v132
    v_mfma_f32_16x16x32_bf16 v[84:87], v[244:247], v[40:43], v[84:87]
    v_and_b32 v129, 0xffff0000, v132
    v_lshlrev_b32 v130, 16, v133
    v_mfma_f32_16x16x32_bf16 v[84:87], v[88:91], v[44:47], v[84:87]
    v_and_b32 v131, 0xffff0000, v133
    v_mfma_f32_16x16x32_bf16 v[84:87], v[92:95], v[48:51], v[84:87]
    s_waitcnt lgkmcnt(1)
    v_mfma_f32_16x16x32_bf16 v[84:87], v[96:99], v[52:55], v[84:87]
    v_add_f32 v112, v112, v116
    s_setprio 1
    ds_write_b128 v3, v[80:83] offset:64
    v_add_f32 v113, v113, v117
    v_add_f32 v114, v114, v118
    v_mfma_f32_16x16x32_bf16 v[84:87], v[100:103], v[56:59], v[84:87]
    v_add_f32 v115, v115, v119
    s_waitcnt lgkmcnt(6)
    v_add_f32 v120, v120, v124
    v_mfma_f32_16x16x32_bf16 v[248:251], v[104:107], v[36:39], v[248:251]
    v_add_f32 v121, v121, v125
    v_mfma_f32_16x16x32_bf16 v[248:251], v[108:111], v[40:43], v[248:251]
    v_add_f32 v122, v122, v126
    v_mfma_f32_16x16x32_bf16 v[248:251], v[136:139], v[44:47], v[248:251]
    v_add_f32 v123, v123, v127
    s_setprio 0
    v_add_f32 v112, v112, v120
    v_mfma_f32_16x16x32_bf16 v[248:251], v[140:143], v[48:51], v[248:251]
    v_add_f32 v113, v113, v121
    v_mfma_f32_16x16x32_bf16 v[248:251], v[144:147], v[52:55], v[248:251]
    v_add_f32 v114, v114, v122
    ds_write_b128 v3, v[84:87] offset:128
    v_add_f32 v115, v115, v123
    v_mfma_f32_16x16x32_bf16 v[248:251], v[148:151], v[56:59], v[248:251]
    v_fmac_f32 v128, v134, v112
    s_waitcnt lgkmcnt(5)
    v_fmac_f32 v129, v134, v113
    v_fmac_f32 v130, v134, v114
    v_mfma_f32_16x16x32_bf16 v[252:255], v[152:155], v[36:39], v[252:255]
    v_fmac_f32 v131, v134, v115
    v_mfma_f32_16x16x32_bf16 v[252:255], v[156:159], v[40:43], v[252:255]
    v_cvt_pk_bf16_f32 v112, v128, v129
    v_mfma_f32_16x16x32_bf16 v[252:255], v[160:163], v[44:47], v[252:255]
    v_cvt_pk_bf16_f32 v113, v130, v131
    v_mfma_f32_16x16x32_bf16 v[252:255], v[164:167], v[48:51], v[252:255]
    s_add_u32 s66, s26, 20480
    s_mov_b64 exec, s[34:35]
    buffer_store_dwordx2 v[112:113], v5, s[44:47], s66 offen
    s_mov_b64 exec, -1
    v_mfma_f32_16x16x32_bf16 v[252:255], v[168:171], v[52:55], v[252:255]
    ds_write_b128 v3, v[248:251] offset:192
    v_mfma_f32_16x16x32_bf16 v[252:255], v[172:175], v[56:59], v[252:255]
    s_nop 7
    ds_write_b128 v3, v[252:255] offset:256
    s_waitcnt lgkmcnt(0)
    s_barrier
    ds_read_b64 v[32:33], v10 offset:5376
    ds_read_b64 v[196:197], v10 offset:8064
    ds_read_b32 v34, v0 offset:128
    ds_read_b32 v198, v0 offset:192
    ds_read_b128 v[12:15], v4 offset:0
    ds_read_b128 v[176:179], v4 offset:21504
    ds_read_b128 v[16:19], v4 offset:5376
    ds_read_b128 v[180:183], v4 offset:26880
    ds_read_b128 v[20:23], v4 offset:10752
    ds_read_b128 v[184:187], v4 offset:32256
    ds_read_b128 v[24:27], v4 offset:16128
    ds_read_b128 v[188:191], v4 offset:37632
    s_waitcnt lgkmcnt(9)
    s_waitcnt lgkmcnt(8)
    v_lshlrev_b32 v28, 16, v32
    v_lshlrev_b32 v192, 16, v196
    v_and_b32 v29, 0xffff0000, v32
    v_and_b32 v193, 0xffff0000, v196
    v_lshlrev_b32 v30, 16, v33
    v_lshlrev_b32 v194, 16, v197
    v_and_b32 v31, 0xffff0000, v33
    v_and_b32 v195, 0xffff0000, v197
    s_waitcnt lgkmcnt(1)
    s_waitcnt lgkmcnt(0)
    v_pk_add_f32 v[12:13], v[12:13], v[16:17]
    v_pk_add_f32 v[176:177], v[176:177], v[180:181]
    v_pk_add_f32 v[14:15], v[14:15], v[18:19]
    v_pk_add_f32 v[178:179], v[178:179], v[182:183]
    v_pk_add_f32 v[20:21], v[20:21], v[24:25]
    v_pk_add_f32 v[184:185], v[184:185], v[188:189]
    v_pk_add_f32 v[22:23], v[22:23], v[26:27]
    v_pk_add_f32 v[186:187], v[186:187], v[190:191]
    v_pk_add_f32 v[12:13], v[12:13], v[20:21]
    v_pk_add_f32 v[176:177], v[176:177], v[184:185]
    v_pk_add_f32 v[14:15], v[14:15], v[22:23]
    v_pk_add_f32 v[178:179], v[178:179], v[186:187]
    v_fmac_f32 v28, v34, v12
    v_fmac_f32 v192, v198, v176
    v_fmac_f32 v29, v34, v13
    v_fmac_f32 v193, v198, v177
    v_fmac_f32 v30, v34, v14
    v_fmac_f32 v194, v198, v178
    v_fmac_f32 v31, v34, v15
    v_fmac_f32 v195, v198, v179
    v_cvt_pk_bf16_f32 v12, v28, v29
    v_cvt_pk_bf16_f32 v176, v192, v193
    v_cvt_pk_bf16_f32 v13, v30, v31
    v_cvt_pk_bf16_f32 v177, v194, v195
    s_add_u32 s66, s26, 40960
    s_mov_b64 exec, s[34:35]
    buffer_store_dwordx2 v[12:13], v5, s[44:47], s66 offen
    s_mov_b64 exec, -1
    s_add_u32 s66, s26, 61440
    s_mov_b64 exec, s[34:35]
    buffer_store_dwordx2 v[176:177], v5, s[44:47], s66 offen
    s_mov_b64 exec, -1
L_finish:
    s_or_b32 s64, s2, s48
    s_cmp_lg_u32 s64, 0
    s_cbranch_scc1 L_end
    v_mov_b32 v6, s54
    v_mov_b32 v7, 0
    s_mov_b64 exec, 1
    buffer_store_dword v6, v7, s[12:15], 0 offen sc1
L_end:
    s_endpgm
L_kv_spin0:
    s_movk_i32 s64, 4096
L_kv_spin:
    buffer_load_dword v29, v28, s[12:15], s64 offen sc1
    s_waitcnt vmcnt(0)
    v_cmp_ne_u32 vcc, s54, v29
    s_sub_u32 s62, s62, 1
    s_max_i32 s62, s62, 0
    s_cmp_eq_u32 s62, 0
    s_cbranch_scc1 L_kv_go
    s_cbranch_vccnz L_kv_spin
L_kv_go:
    buffer_load_dwordx4 v[240:243], v2, s[12:15], s34 offen offset:0 sc1
    buffer_load_dwordx4 v[144:147], v142, s[12:15], s3 offen offset:0 sc1
    buffer_load_dwordx4 v[176:179], v143, s[12:15], s35 offen offset:0 sc1
    buffer_load_dwordx4 v[180:183], v143, s[12:15], s35 offen offset:672 sc1
    buffer_load_dwordx4 v[148:151], v142, s[12:15], s3 offen offset:1024 sc1
    buffer_load_dwordx4 v[184:187], v143, s[12:15], s35 offen offset:1344 sc1
    buffer_load_dwordx4 v[188:191], v143, s[12:15], s35 offen offset:2016 sc1
    buffer_load_dwordx4 v[244:247], v2, s[12:15], s34 offen offset:1024 sc1
    buffer_load_dwordx4 v[152:155], v142, s[12:15], s3 offen offset:2048 sc1
    buffer_load_dwordx4 v[192:195], v143, s[12:15], s35 offen offset:2688 sc1
    buffer_load_dwordx4 v[196:199], v143, s[12:15], s35 offen offset:3360 sc1
    buffer_load_dwordx4 v[156:159], v142, s[12:15], s3 offen offset:3072 sc1
    buffer_load_dwordx4 v[200:203], v143, s[12:15], s35 offen offset:4032 sc1
    s_add_u32 s65, s35, 4096
    buffer_load_dwordx4 v[204:207], v143, s[12:15], s65 offen offset:608 sc1
    s_branch L_kv_done
L_flags:
    v_mov_b32 v116, s54
    v_lshlrev_b32 v117, 2, v1
    s_lshl_b32 s66, s20, 2
    s_add_u32 s66, s66, 8192
    s_mov_b64 exec, 31
    buffer_store_dword v116, v117, s[12:15], s66 offen sc1
    s_mov_b64 exec, -1
    s_branch L_flags_r
L_gflag:
    s_getreg_b32 s64, hwreg(HW_REG_XCC_ID)
    v_mov_b32 v136, s54
    v_mov_b32 v137, s64
    v_mov_b32 v138, 0
    s_lshl_b32 s65, s51, 3
    s_add_u32 s65, s65, s52
    s_lshl_b32 s65, s65, 3
    s_add_u32 s65, s65, 16384
    s_mov_b64 exec, 1
    buffer_store_dwordx2 v[136:137], v138, s[12:15], s65 offen sc1
    s_mov_b64 exec, -1
    s_branch L_gflag_r
L_poll:
    s_mul_i32 s65, s52, 240
    s_add_u32 s65, s65, 8192
    buffer_load_dword v136, v140, s[12:15], s65 offen sc1
    s_mul_i32 s65, s48, 240
    s_add_u32 s65, s65, 10112
    buffer_load_dword v137, v140, s[12:15], s65 offen sc1
    s_movk_i32 s65, 12032
    buffer_load_dwordx4 v[132:135], v141, s[12:15], s65 offen sc1
    s_waitcnt vmcnt(0)
    v_max3_u32 v138, v136, v137, s54
    v_min3_u32 v136, v136, v137, s54
    v_max3_u32 v138, v138, v132, v133
    v_min3_u32 v136, v136, v132, v133
    v_max3_u32 v138, v138, v134, v135
    v_min3_u32 v136, v136, v134, v135
    v_cmp_ne_u32 vcc, v136, v138
    s_sub_u32 s62, s62, 1
    s_max_i32 s62, s62, 0
    s_cmp_eq_u32 s62, 0
    s_cbranch_scc1 L_poll_r
    s_cbranch_vccnz L_poll
    s_branch L_poll_r
L_gp:
    s_lshl_b32 s65, s51, 6
    s_add_u32 s65, s65, 16384
    buffer_load_dwordx2 v[140:141], v142, s[12:15], s65 offen sc1
    s_waitcnt vmcnt(0)
    v_cmp_ne_u32 vcc, s54, v140
    s_sub_u32 s62, s62, 1
    s_max_i32 s62, s62, 0
    s_cmp_eq_u32 s62, 0
    s_cbranch_scc1 L_gp_r
    s_cbranch_vccnz L_gp
    s_branch L_gp_r
L_fallback:
    s_mov_b32 s61, 1
    s_mov_b32 s30, 0
    s_waitcnt vmcnt(0)
    v_mov_b32 v28, v9
    v_mov_b32 v29, v10
    v_mov_b32 v30, v142
    v_mov_b32 v31, v143
    v_and_b32 v9, 31, v1
    v_lshrrev_b32 v10, 5, v1
    v_lshlrev_b32 v142, 4, v10
    v_lshl_add_u32 v142, v9, 5, v142
    v_mul_u32_u24 v143, 336, v10
    v_lshl_add_u32 v143, v9, 4, v143
    v_add_u32 v9, 11, v9
    v_and_b32 v9, 32, v9
    v_lshl_add_u32 v143, v9, 23, v143
    buffer_load_dwordx4 v[240:243], v2, s[12:15], s34 offen offset:0 sc1
    buffer_load_dwordx4 v[144:147], v142, s[12:15], s3 offen offset:0 sc1
    buffer_load_dwordx4 v[176:179], v143, s[12:15], s35 offen offset:0 sc1
    buffer_load_dwordx4 v[180:183], v143, s[12:15], s35 offen offset:672 sc1
    buffer_load_dwordx4 v[148:151], v142, s[12:15], s3 offen offset:1024 sc1
    buffer_load_dwordx4 v[184:187], v143, s[12:15], s35 offen offset:1344 sc1
    buffer_load_dwordx4 v[188:191], v143, s[12:15], s35 offen offset:2016 sc1
    buffer_load_dwordx4 v[244:247], v2, s[12:15], s34 offen offset:1024 sc1
    buffer_load_dwordx4 v[152:155], v142, s[12:15], s3 offen offset:2048 sc1
    buffer_load_dwordx4 v[192:195], v143, s[12:15], s35 offen offset:2688 sc1
    buffer_load_dwordx4 v[196:199], v143, s[12:15], s35 offen offset:3360 sc1
    buffer_load_dwordx4 v[156:159], v142, s[12:15], s3 offen offset:3072 sc1
    buffer_load_dwordx4 v[200:203], v143, s[12:15], s35 offen offset:4032 sc1
    s_add_u32 s65, s35, 4096
    buffer_load_dwordx4 v[204:207], v143, s[12:15], s65 offen offset:608 sc1
    buffer_load_dwordx4 v[248:251], v2, s[12:15], s34 offen offset:2048 sc1
    s_add_u32 s65, s3, 4096
    buffer_load_dwordx4 v[160:163], v142, s[12:15], s65 offen offset:0 sc1
    s_add_u32 s65, s35, 4096
    buffer_load_dwordx4 v[208:211], v143, s[12:15], s65 offen offset:1280 sc1
    s_add_u32 s65, s35, 4096
    buffer_load_dwordx4 v[212:215], v143, s[12:15], s65 offen offset:1952 sc1
    s_add_u32 s65, s3, 4096
    buffer_load_dwordx4 v[164:167], v142, s[12:15], s65 offen offset:1024 sc1
    s_add_u32 s65, s35, 4096
    buffer_load_dwordx4 v[216:219], v143, s[12:15], s65 offen offset:2624 sc1
    s_add_u32 s65, s35, 4096
    buffer_load_dwordx4 v[220:223], v143, s[12:15], s65 offen offset:3296 sc1
    buffer_load_dwordx4 v[252:255], v2, s[12:15], s34 offen offset:3072 sc1
    s_add_u32 s65, s3, 4096
    buffer_load_dwordx4 v[168:171], v142, s[12:15], s65 offen offset:2048 sc1
    s_add_u32 s65, s35, 4096
    buffer_load_dwordx4 v[224:227], v143, s[12:15], s65 offen offset:3968 sc1
    s_add_u32 s65, s35, 8192
    buffer_load_dwordx4 v[228:231], v143, s[12:15], s65 offen offset:544 sc1
    s_add_u32 s65, s3, 4096
    buffer_load_dwordx4 v[172:175], v142, s[12:15], s65 offen offset:3072 sc1
    s_add_u32 s65, s35, 8192
    buffer_load_dwordx4 v[232:235], v143, s[12:15], s65 offen offset:1216 sc1
    s_add_u32 s65, s35, 8192
    buffer_load_dwordx4 v[236:239], v143, s[12:15], s65 offen offset:1888 sc1
    v_mov_b32 v9, v28
    v_mov_b32 v10, v29
    v_mov_b32 v142, v30
    v_mov_b32 v143, v31
    s_lshl_b32 s64, s49, 8
    s_add_u32 s64, s64, 158976
    v_lshl_add_u32 v24, v1, 2, s64
    v_mov_b32 v25, 0xff800000
    ds_write_b32 v24, v25
    s_waitcnt vmcnt(0) lgkmcnt(0)
    s_barrier
    s_mov_b32 s75, 0
L_fb_loop:
    s_mov_b32 s64, s75
    v_mad_u32_u24 v7, v11, s64, v10
    s_mul_i32 s64, s64, 1280
    v_add_u32 v6, s64, v9
    ds_read2_b64 v[12:15], v6 offset0:0 offset1:32
    ds_read_b64 v[16:17], v7 offset:1024
    s_waitcnt lgkmcnt(0)
    s_mov_b32 exec_lo, 0
    v_mov_b32 v16, 0
    v_mov_b32 v17, 0
    s_mov_b32 exec_lo, -1
    v_mfma_f32_32x32x16_bf16 v[32:47], v[144:147], v[12:15], 0
    v_mfma_f32_32x32x8_bf16 v[32:47], v[240:241], v[16:17], v[32:47]
    s_nop 11
    v_max3_f32 v24, v32, v33, v34
    v_max_f32 v24, v24, v35
    v_max3_f32 v24, v24, v36, v37
    v_max3_f32 v24, v24, v38, v39
    v_max3_f32 v24, v24, v40, v41
    v_max3_f32 v24, v24, v42, v43
    v_max3_f32 v24, v24, v44, v45
    v_max3_f32 v24, v24, v46, v47
    v_mfma_f32_32x32x16_bf16 v[32:47], v[148:151], v[12:15], 0
    v_mfma_f32_32x32x8_bf16 v[32:47], v[242:243], v[16:17], v[32:47]
    s_nop 11
    v_max3_f32 v24, v24, v32, v33
    v_max3_f32 v24, v24, v34, v35
    v_max3_f32 v24, v24, v36, v37
    v_max3_f32 v24, v24, v38, v39
    v_max3_f32 v24, v24, v40, v41
    v_max3_f32 v24, v24, v42, v43
    v_max3_f32 v24, v24, v44, v45
    v_max3_f32 v24, v24, v46, v47
    v_mfma_f32_32x32x16_bf16 v[32:47], v[152:155], v[12:15], 0
    v_mfma_f32_32x32x8_bf16 v[32:47], v[244:245], v[16:17], v[32:47]
    s_nop 11
    v_max3_f32 v24, v24, v32, v33
    v_max3_f32 v24, v24, v34, v35
    v_max3_f32 v24, v24, v36, v37
    v_max3_f32 v24, v24, v38, v39
    v_max3_f32 v24, v24, v40, v41
    v_max3_f32 v24, v24, v42, v43
    v_max3_f32 v24, v24, v44, v45
    v_max3_f32 v24, v24, v46, v47
    v_mfma_f32_32x32x16_bf16 v[32:47], v[156:159], v[12:15], 0
    v_mfma_f32_32x32x8_bf16 v[32:47], v[246:247], v[16:17], v[32:47]
    s_nop 11
    v_max3_f32 v24, v24, v32, v33
    v_max3_f32 v24, v24, v34, v35
    v_max3_f32 v24, v24, v36, v37
    v_max3_f32 v24, v24, v38, v39
    v_max3_f32 v24, v24, v40, v41
    v_max3_f32 v24, v24, v42, v43
    v_max3_f32 v24, v24, v44, v45
    v_max3_f32 v24, v24, v46, v47
    v_mfma_f32_32x32x16_bf16 v[32:47], v[160:163], v[12:15], 0
    v_mfma_f32_32x32x8_bf16 v[32:47], v[248:249], v[16:17], v[32:47]
    s_nop 11
    v_max3_f32 v24, v24, v32, v33
    v_max3_f32 v24, v24, v34, v35
    v_max3_f32 v24, v24, v36, v37
    v_max3_f32 v24, v24, v38, v39
    v_max3_f32 v24, v24, v40, v41
    v_max3_f32 v24, v24, v42, v43
    v_max3_f32 v24, v24, v44, v45
    v_max3_f32 v24, v24, v46, v47
    v_mfma_f32_32x32x16_bf16 v[32:47], v[164:167], v[12:15], 0
    v_mfma_f32_32x32x8_bf16 v[32:47], v[250:251], v[16:17], v[32:47]
    s_nop 11
    v_max3_f32 v24, v24, v32, v33
    v_max3_f32 v24, v24, v34, v35
    v_max3_f32 v24, v24, v36, v37
    v_max3_f32 v24, v24, v38, v39
    v_max3_f32 v24, v24, v40, v41
    v_max3_f32 v24, v24, v42, v43
    v_max3_f32 v24, v24, v44, v45
    v_max3_f32 v24, v24, v46, v47
    v_mfma_f32_32x32x16_bf16 v[32:47], v[168:171], v[12:15], 0
    v_mfma_f32_32x32x8_bf16 v[32:47], v[252:253], v[16:17], v[32:47]
    s_nop 11
    v_max3_f32 v24, v24, v32, v33
    v_max3_f32 v24, v24, v34, v35
    v_max3_f32 v24, v24, v36, v37
    v_max3_f32 v24, v24, v38, v39
    v_max3_f32 v24, v24, v40, v41
    v_max3_f32 v24, v24, v42, v43
    v_max3_f32 v24, v24, v44, v45
    v_max3_f32 v24, v24, v46, v47
    v_mfma_f32_32x32x16_bf16 v[32:47], v[172:175], v[12:15], 0
    v_mfma_f32_32x32x8_bf16 v[32:47], v[254:255], v[16:17], v[32:47]
    s_nop 11
    v_max3_f32 v24, v24, v32, v33
    v_max3_f32 v24, v24, v34, v35
    v_max3_f32 v24, v24, v36, v37
    v_max3_f32 v24, v24, v38, v39
    v_max3_f32 v24, v24, v40, v41
    v_max3_f32 v24, v24, v42, v43
    v_max3_f32 v24, v24, v44, v45
    v_max3_f32 v24, v24, v46, v47
    v_and_b32 v25, 31, v1
    s_lshl_b32 s64, s75, 7
    s_add_u32 s64, s64, 158976
    v_lshl_add_u32 v25, v25, 2, s64
    ds_max_f32 v25, v24
    s_add_u32 s75, s75, 1
    s_cmp_lt_u32 s75, 8
    s_cbranch_scc1 L_fb_loop
    s_waitcnt lgkmcnt(0)
    s_barrier
    v_and_b32 v25, 31, v1
    s_lshl_b32 s64, s48, 7
    s_add_u32 s64, s64, 158976
    v_lshl_add_u32 v25, v25, 2, s64
    ds_read_b32 v24, v25
    s_mov_b32 s64, s48
    v_mad_u32_u24 v7, v11, s64, v10
    s_mul_i32 s64, s64, 1280
    v_add_u32 v6, s64, v9
    s_waitcnt lgkmcnt(0)
    v_xor_b32 v24, 0x80000000, v24
    v_and_b32 v25, 0xffff0000, v24
    v_sub_f32 v24, v24, v25
    v_and_b32 v26, 0xffff0000, v24
    v_sub_f32 v24, v24, v26
    s_mov_b32 exec_lo, 0
    v_lshrrev_b32 v25, 16, v25
    v_or_b32 v16, v25, v26
    v_lshrrev_b32 v17, 16, v24
    ds_write_b64 v7, v[16:17] offset:1024
    s_mov_b32 exec_lo, -1
    s_waitcnt lgkmcnt(0)
    s_barrier
    s_add_u32 s64, s48, 1
    s_and_b32 s64, s64, 7
    v_mad_u32_u24 v7, v11, s64, v10
    s_mul_i32 s64, s64, 1280
    v_add_u32 v6, s64, v9
    ds_read2_b64 v[12:15], v6 offset0:0 offset1:32
    ds_read_b64 v[16:17], v7 offset:1024
    v_mov_b32 v24, 0
    v_mov_b32 v25, 0
    v_mov_b32 v26, 0
    v_mov_b32 v27, 0
    v_mov_b32 v28, 0
    v_mov_b32 v29, 0
    v_mov_b32 v30, 0
    v_mov_b32 v31, 0
    v_mov_b32 v64, 0
    v_mov_b32 v65, 0
    v_mov_b32 v66, 0
    v_mov_b32 v67, 0
    v_mov_b32 v68, 0
    v_mov_b32 v69, 0
    v_mov_b32 v70, 0
    v_mov_b32 v71, 0
    v_mov_b32 v72, 0
    v_mov_b32 v73, 0
    v_mov_b32 v74, 0
    v_mov_b32 v75, 0
    v_mov_b32 v76, 0
    v_mov_b32 v77, 0
    v_mov_b32 v78, 0
    v_mov_b32 v79, 0
    v_mov_b32 v80, 0
    v_mov_b32 v81, 0
    v_mov_b32 v82, 0
    v_mov_b32 v83, 0
    v_mov_b32 v84, 0
    v_mov_b32 v85, 0
    v_mov_b32 v86, 0
    v_mov_b32 v87, 0
    v_mov_b32 v18, 0
    v_mov_b32 v19, 0
    v_mov_b32 v20, 0
    v_mov_b32 v21, 0
    s_mov_b32 s64, s48
    s_mul_i32 s64, s64, 3072
    s_add_u32 s64, s64, 114688
    v_add_u32 v8, s64, v2
    s_mov_b32 s58, 0
    s_add_u32 s76, s48, 1
    s_and_b32 s76, s76, 7
    s_waitcnt lgkmcnt(0)
    v_mfma_f32_32x32x16_bf16 v[32:47], v[144:147], v[12:15], 0
    v_mfma_f32_32x32x8_bf16 v[32:47], v[240:241], v[16:17], v[32:47]
    s_nop 7
    s_nop 3
L_fb_att:
    s_mov_b32 s75, s76
    s_add_u32 s76, s76, 1
    s_and_b32 s76, s76, 7
    s_setprio 2
    v_exp_f32 v32, v32
    v_exp_f32 v33, v33
    v_exp_f32 v34, v34
    v_mfma_f32_32x32x16_bf16 v[64:79], v[236:239], v[28:31], v[64:79]
    v_exp_f32 v35, v35
    v_exp_f32 v36, v36
    v_exp_f32 v37, v37
    v_exp_f32 v38, v38
    v_mfma_f32_32x32x16_bf16 v[48:63], v[148:151], v[12:15], 0
    v_exp_f32 v39, v39
    v_cvt_pk_bf16_f32 v24, v32, v33
    v_cvt_pk_bf16_f32 v25, v34, v35
    v_cvt_pk_bf16_f32 v26, v36, v37
    v_exp_f32 v40, v40
    v_cvt_pk_bf16_f32 v27, v38, v39
    v_mfma_f32_32x32x8_bf16 v[48:63], v[242:243], v[16:17], v[48:63]
    v_exp_f32 v41, v41
    v_exp_f32 v42, v42
    v_exp_f32 v43, v43
    v_exp_f32 v44, v44
    v_pk_add_f32 v[18:19], v[72:73], v[18:19]
    v_pk_add_f32 v[20:21], v[74:75], v[20:21]
    v_pk_add_f32 v[80:81], v[64:65], v[80:81]
    v_pk_add_f32 v[82:83], v[66:67], v[82:83]
    v_pk_add_f32 v[84:85], v[68:69], v[84:85]
    v_pk_add_f32 v[86:87], v[70:71], v[86:87]
    v_mfma_f32_32x32x16_bf16 v[64:79], v[176:179], v[24:27], 0
    ds_write_b128 v8, v[80:83]
    v_exp_f32 v45, v45
    v_exp_f32 v46, v46
    v_exp_f32 v47, v47
    v_cvt_pk_bf16_f32 v28, v40, v41
    v_cvt_pk_bf16_f32 v29, v42, v43
    v_cvt_pk_bf16_f32 v30, v44, v45
    v_cvt_pk_bf16_f32 v31, v46, v47
    s_setprio 1
    v_exp_f32 v48, v48
    v_exp_f32 v49, v49
    v_exp_f32 v50, v50
    v_mfma_f32_32x32x16_bf16 v[64:79], v[180:183], v[28:31], v[64:79]
    ds_write_b128 v8, v[84:87] offset:1024
    v_exp_f32 v51, v51
    v_exp_f32 v52, v52
    v_exp_f32 v53, v53
    v_exp_f32 v54, v54
    v_mfma_f32_32x32x16_bf16 v[32:47], v[152:155], v[12:15], 0
    ds_write_b128 v8, v[18:21] offset:2048
    v_exp_f32 v55, v55
    v_cvt_pk_bf16_f32 v24, v48, v49
    v_cvt_pk_bf16_f32 v25, v50, v51
    v_cvt_pk_bf16_f32 v26, v52, v53
    v_exp_f32 v56, v56
    v_cvt_pk_bf16_f32 v27, v54, v55
    v_mfma_f32_32x32x8_bf16 v[32:47], v[244:245], v[16:17], v[32:47]
    v_exp_f32 v57, v57
    v_exp_f32 v58, v58
    v_exp_f32 v59, v59
    v_exp_f32 v60, v60
    v_mfma_f32_32x32x16_bf16 v[64:79], v[184:187], v[24:27], v[64:79]
    v_exp_f32 v61, v61
    v_exp_f32 v62, v62
    v_exp_f32 v63, v63
    v_cvt_pk_bf16_f32 v28, v56, v57
    v_cvt_pk_bf16_f32 v29, v58, v59
    v_cvt_pk_bf16_f32 v30, v60, v61
    v_cvt_pk_bf16_f32 v31, v62, v63
    s_setprio 0
    v_exp_f32 v32, v32
    v_exp_f32 v33, v33
    v_exp_f32 v34, v34
    v_mfma_f32_32x32x16_bf16 v[64:79], v[188:191], v[28:31], v[64:79]
    v_exp_f32 v35, v35
    v_exp_f32 v36, v36
    v_exp_f32 v37, v37
    v_exp_f32 v38, v38
    v_mfma_f32_32x32x16_bf16 v[48:63], v[156:159], v[12:15], 0
    v_exp_f32 v39, v39
    v_cvt_pk_bf16_f32 v24, v32, v33
    v_cvt_pk_bf16_f32 v25, v34, v35
    v_cvt_pk_bf16_f32 v26, v36, v37
    v_exp_f32 v40, v40
    v_cvt_pk_bf16_f32 v27, v38, v39
    v_mfma_f32_32x32x8_bf16 v[48:63], v[246:247], v[16:17], v[48:63]
    v_exp_f32 v41, v41
    v_exp_f32 v42, v42
    v_exp_f32 v43, v43
    v_exp_f32 v44, v44
    v_mfma_f32_32x32x16_bf16 v[64:79], v[192:195], v[24:27], v[64:79]
    v_exp_f32 v45, v45
    v_exp_f32 v46, v46
    v_exp_f32 v47, v47
    v_cvt_pk_bf16_f32 v28, v40, v41
    v_cvt_pk_bf16_f32 v29, v42, v43
    v_cvt_pk_bf16_f32 v30, v44, v45
    v_cvt_pk_bf16_f32 v31, v46, v47
    s_setprio 3
    s_waitcnt lgkmcnt(0)
    s_barrier
    s_mov_b32 s64, s75
    s_mul_i32 s64, s64, 3072
    s_add_u32 s64, s64, 114688
    v_add_u32 v8, s64, v2
    v_exp_f32 v48, v48
    v_exp_f32 v49, v49
    v_exp_f32 v50, v50
    v_mfma_f32_32x32x16_bf16 v[64:79], v[196:199], v[28:31], v[64:79]
    ds_read_b128 v[80:83], v8
    v_exp_f32 v51, v51
    v_exp_f32 v52, v52
    v_exp_f32 v53, v53
    v_exp_f32 v54, v54
    v_mfma_f32_32x32x16_bf16 v[32:47], v[160:163], v[12:15], 0
    ds_read_b128 v[84:87], v8 offset:1024
    v_exp_f32 v55, v55
    v_cvt_pk_bf16_f32 v24, v48, v49
    v_cvt_pk_bf16_f32 v25, v50, v51
    v_cvt_pk_bf16_f32 v26, v52, v53
    v_exp_f32 v56, v56
    v_cvt_pk_bf16_f32 v27, v54, v55
    v_mfma_f32_32x32x8_bf16 v[32:47], v[248:249], v[16:17], v[32:47]
    ds_read_b128 v[18:21], v8 offset:2048
    v_exp_f32 v57, v57
    v_exp_f32 v58, v58
    v_exp_f32 v59, v59
    v_exp_f32 v60, v60
    v_mfma_f32_32x32x16_bf16 v[64:79], v[200:203], v[24:27], v[64:79]
    v_exp_f32 v61, v61
    v_exp_f32 v62, v62
    v_exp_f32 v63, v63
    v_cvt_pk_bf16_f32 v28, v56, v57
    v_cvt_pk_bf16_f32 v29, v58, v59
    v_cvt_pk_bf16_f32 v30, v60, v61
    v_cvt_pk_bf16_f32 v31, v62, v63
    v_exp_f32 v32, v32
    v_exp_f32 v33, v33
    v_exp_f32 v34, v34
    v_mfma_f32_32x32x16_bf16 v[64:79], v[204:207], v[28:31], v[64:79]
    v_exp_f32 v35, v35
    v_exp_f32 v36, v36
    v_exp_f32 v37, v37
    v_exp_f32 v38, v38
    v_mfma_f32_32x32x16_bf16 v[48:63], v[164:167], v[12:15], 0
    v_exp_f32 v39, v39
    v_cvt_pk_bf16_f32 v24, v32, v33
    v_cvt_pk_bf16_f32 v25, v34, v35
    v_cvt_pk_bf16_f32 v26, v36, v37
    v_exp_f32 v40, v40
    v_cvt_pk_bf16_f32 v27, v38, v39
    v_mfma_f32_32x32x8_bf16 v[48:63], v[250:251], v[16:17], v[48:63]
    v_exp_f32 v41, v41
    v_exp_f32 v42, v42
    v_exp_f32 v43, v43
    v_exp_f32 v44, v44
    v_mfma_f32_32x32x16_bf16 v[64:79], v[208:211], v[24:27], v[64:79]
    v_exp_f32 v45, v45
    v_exp_f32 v46, v46
    v_exp_f32 v47, v47
    v_cvt_pk_bf16_f32 v28, v40, v41
    v_cvt_pk_bf16_f32 v29, v42, v43
    v_cvt_pk_bf16_f32 v30, v44, v45
    v_cvt_pk_bf16_f32 v31, v46, v47
    v_exp_f32 v48, v48
    v_exp_f32 v49, v49
    v_exp_f32 v50, v50
    v_mfma_f32_32x32x16_bf16 v[64:79], v[212:215], v[28:31], v[64:79]
    v_exp_f32 v51, v51
    v_exp_f32 v52, v52
    v_exp_f32 v53, v53
    v_exp_f32 v54, v54
    v_mfma_f32_32x32x16_bf16 v[32:47], v[168:171], v[12:15], 0
    v_exp_f32 v55, v55
    v_cvt_pk_bf16_f32 v24, v48, v49
    v_cvt_pk_bf16_f32 v25, v50, v51
    v_cvt_pk_bf16_f32 v26, v52, v53
    v_exp_f32 v56, v56
    v_cvt_pk_bf16_f32 v27, v54, v55
    v_mfma_f32_32x32x8_bf16 v[32:47], v[252:253], v[16:17], v[32:47]
    s_mov_b32 s64, s76
    v_mad_u32_u24 v7, v11, s64, v10
    s_mul_i32 s64, s64, 1280
    v_add_u32 v6, s64, v9
    v_exp_f32 v57, v57
    v_exp_f32 v58, v58
    v_exp_f32 v59, v59
    v_exp_f32 v60, v60
    v_mfma_f32_32x32x16_bf16 v[64:79], v[216:219], v[24:27], v[64:79]
    v_exp_f32 v61, v61
    v_exp_f32 v62, v62
    v_exp_f32 v63, v63
    v_cvt_pk_bf16_f32 v28, v56, v57
    v_cvt_pk_bf16_f32 v29, v58, v59
    v_cvt_pk_bf16_f32 v30, v60, v61
    v_cvt_pk_bf16_f32 v31, v62, v63
    v_exp_f32 v32, v32
    v_exp_f32 v33, v33
    v_exp_f32 v34, v34
    v_mfma_f32_32x32x16_bf16 v[64:79], v[220:223], v[28:31], v[64:79]
    v_exp_f32 v35, v35
    v_exp_f32 v36, v36
    v_exp_f32 v37, v37
    v_exp_f32 v38, v38
    v_mfma_f32_32x32x16_bf16 v[48:63], v[172:175], v[12:15], 0
    ds_read2_b64 v[12:15], v6 offset0:0 offset1:32
    v_exp_f32 v39, v39
    v_cvt_pk_bf16_f32 v24, v32, v33
    v_cvt_pk_bf16_f32 v25, v34, v35
    v_cvt_pk_bf16_f32 v26, v36, v37
    v_exp_f32 v40, v40
    v_cvt_pk_bf16_f32 v27, v38, v39
    v_mfma_f32_32x32x8_bf16 v[48:63], v[254:255], v[16:17], v[48:63]
    ds_read_b64 v[16:17], v7 offset:1024
    v_exp_f32 v41, v41
    v_exp_f32 v42, v42
    v_exp_f32 v43, v43
    v_exp_f32 v44, v44
    v_mfma_f32_32x32x16_bf16 v[64:79], v[224:227], v[24:27], v[64:79]
    v_exp_f32 v45, v45
    v_exp_f32 v46, v46
    v_exp_f32 v47, v47
    v_cvt_pk_bf16_f32 v28, v40, v41
    v_cvt_pk_bf16_f32 v29, v42, v43
    v_cvt_pk_bf16_f32 v30, v44, v45
    v_cvt_pk_bf16_f32 v31, v46, v47
    v_exp_f32 v48, v48
    v_exp_f32 v49, v49
    v_exp_f32 v50, v50
    v_mfma_f32_32x32x16_bf16 v[64:79], v[228:231], v[28:31], v[64:79]
    v_exp_f32 v51, v51
    v_exp_f32 v52, v52
    v_exp_f32 v53, v53
    v_exp_f32 v54, v54
    s_waitcnt lgkmcnt(0)
    v_mfma_f32_32x32x16_bf16 v[32:47], v[144:147], v[12:15], 0
    v_exp_f32 v55, v55
    v_cvt_pk_bf16_f32 v24, v48, v49
    v_cvt_pk_bf16_f32 v25, v50, v51
    v_cvt_pk_bf16_f32 v26, v52, v53
    v_exp_f32 v56, v56
    v_cvt_pk_bf16_f32 v27, v54, v55
    v_mfma_f32_32x32x8_bf16 v[32:47], v[240:241], v[16:17], v[32:47]
    v_exp_f32 v57, v57
    v_exp_f32 v58, v58
    v_exp_f32 v59, v59
    v_exp_f32 v60, v60
    v_mfma_f32_32x32x16_bf16 v[64:79], v[232:235], v[24:27], v[64:79]
    v_exp_f32 v61, v61
    v_exp_f32 v62, v62
    v_exp_f32 v63, v63
    v_cvt_pk_bf16_f32 v28, v56, v57
    v_cvt_pk_bf16_f32 v29, v58, v59
    v_cvt_pk_bf16_f32 v30, v60, v61
    v_cvt_pk_bf16_f32 v31, v62, v63
    s_add_u32 s58, s58, 1
    s_cmp_lt_u32 s58, 8
    s_cbranch_scc1 L_fb_att
    s_add_u32 s65, s21, 16384
    buffer_load_dwordx4 v[144:147], v2, s[12:15], s65 offen offset:0 sc1
    s_add_u32 s65, s73, 20480
    buffer_load_dwordx4 v[148:151], v2, s[12:15], s65 offen offset:0 sc1
    s_add_u32 s65, s74, 20480
    buffer_load_dwordx4 v[152:155], v2, s[12:15], s65 offen offset:0 sc1
    s_add_u32 s65, s21, 20480
    buffer_load_dwordx4 v[156:159], v2, s[12:15], s65 offen offset:0 sc1
    s_add_u32 s65, s73, 24576
    buffer_load_dwordx4 v[160:163], v2, s[12:15], s65 offen offset:0 sc1
    s_add_u32 s65, s74, 24576
    buffer_load_dwordx4 v[164:167], v2, s[12:15], s65 offen offset:0 sc1
    s_add_u32 s65, s21, 24576
    buffer_load_dwordx4 v[168:171], v2, s[12:15], s65 offen offset:0 sc1
    s_add_u32 s65, s73, 28672
    buffer_load_dwordx4 v[172:175], v2, s[12:15], s65 offen offset:0 sc1
    s_add_u32 s65, s74, 28672
    buffer_load_dwordx4 v[176:179], v2, s[12:15], s65 offen offset:0 sc1
    s_add_u32 s65, s21, 28672
    buffer_load_dwordx4 v[180:183], v2, s[12:15], s65 offen offset:0 sc1
    s_add_u32 s65, s73, 32768
    buffer_load_dwordx4 v[184:187], v2, s[12:15], s65 offen offset:0 sc1
    s_add_u32 s65, s74, 32768
    buffer_load_dwordx4 v[188:191], v2, s[12:15], s65 offen offset:0 sc1
    s_add_u32 s65, s21, 32768
    buffer_load_dwordx4 v[192:195], v2, s[12:15], s65 offen offset:0 sc1
    s_add_u32 s65, s73, 36864
    buffer_load_dwordx4 v[196:199], v2, s[12:15], s65 offen offset:0 sc1
    s_add_u32 s65, s74, 36864
    buffer_load_dwordx4 v[200:203], v2, s[12:15], s65 offen offset:0 sc1
    s_add_u32 s65, s21, 36864
    buffer_load_dwordx4 v[204:207], v2, s[12:15], s65 offen offset:0 sc1
    s_branch L_att_end
L_ps_43:
    buffer_store_dwordx4 v[56:59], v5, s[12:15], s56 offen sc1
    s_mov_b32 exec_hi, 0
    buffer_store_dwordx2 v[60:61], v5, s[12:15], s57 offen sc1
    s_branch L_pj_44
L_o_bad:
    s_cmp_lg_u32 s31, 0
    s_cbranch_scc1 L_o_ok
    s_cmp_lg_u32 s61, 0
    s_cbranch_scc1 L_o_st
    s_mov_b32 s31, 1
    ds_write_b32 v6, v7
    s_branch L_o_st
L_O0:
    s_sub_u32 s62, s62, 1
    s_max_i32 s62, s62, 0
    s_cmp_eq_u32 s62, 0
    s_cbranch_scc1 L_O0_x
    buffer_load_dwordx4 v[208:211], v2, s[12:15], s16 offen offset:0 sc1
    buffer_load_dwordx4 v[212:215], v2, s[12:15], s16 offen offset:1024 sc1
    buffer_load_dwordx4 v[216:219], v2, s[12:15], s16 offen offset:2048 sc1
    buffer_load_dwordx4 v[220:223], v2, s[12:15], s16 offen offset:3072 sc1
    buffer_load_dwordx4 v[224:227], v2, s[12:15], s33 offen offset:0 sc1
    buffer_load_dwordx4 v[228:231], v2, s[12:15], s33 offen offset:1024 sc1
    s_waitcnt vmcnt(0)
    v_max_u32 v11, v208, v212
    v_cmp_eq_u32 vcc, -1, v11
    s_cbranch_vccnz L_O0
    s_branch L_O0_x
L_O2:
    s_sub_u32 s62, s62, 1
    s_max_i32 s62, s62, 0
    s_cmp_eq_u32 s62, 0
    s_cbranch_scc1 L_O2_x
    buffer_load_dwordx4 v[216:219], v2, s[12:15], s16 offen offset:2048 sc1
    buffer_load_dwordx4 v[220:223], v2, s[12:15], s16 offen offset:3072 sc1
    buffer_load_dwordx4 v[224:227], v2, s[12:15], s33 offen offset:0 sc1
    buffer_load_dwordx4 v[228:231], v2, s[12:15], s33 offen offset:1024 sc1
    buffer_load_dwordx4 v[232:235], v2, s[12:15], s33 offen offset:2048 sc1
    buffer_load_dwordx4 v[236:239], v2, s[12:15], s33 offen offset:3072 sc1
    s_waitcnt vmcnt(0)
    v_max_u32 v11, v216, v220
    v_cmp_eq_u32 vcc, -1, v11
    s_cbranch_vccnz L_O2
    s_branch L_O2_x
L_O4:
    s_sub_u32 s62, s62, 1
    s_max_i32 s62, s62, 0
    s_cmp_eq_u32 s62, 0
    s_cbranch_scc1 L_O4_x
    buffer_load_dwordx4 v[224:227], v2, s[12:15], s33 offen offset:0 sc1
    buffer_load_dwordx4 v[228:231], v2, s[12:15], s33 offen offset:1024 sc1
    buffer_load_dwordx4 v[232:235], v2, s[12:15], s33 offen offset:2048 sc1
    buffer_load_dwordx4 v[236:239], v2, s[12:15], s33 offen offset:3072 sc1
    buffer_load_dwordx4 v[240:243], v2, s[12:15], s78 offen offset:0 sc1
    buffer_load_dwordx4 v[244:247], v2, s[12:15], s78 offen offset:1024 sc1
    s_waitcnt vmcnt(0)
    v_max_u32 v11, v224, v228
    v_cmp_eq_u32 vcc, -1, v11
    s_cbranch_vccnz L_O4
    s_branch L_O4_x
L_O6:
    s_sub_u32 s62, s62, 1
    s_max_i32 s62, s62, 0
    s_cmp_eq_u32 s62, 0
    s_cbranch_scc1 L_O6_x
    buffer_load_dwordx4 v[232:235], v2, s[12:15], s33 offen offset:2048 sc1
    buffer_load_dwordx4 v[236:239], v2, s[12:15], s33 offen offset:3072 sc1
    buffer_load_dwordx4 v[240:243], v2, s[12:15], s78 offen offset:0 sc1
    buffer_load_dwordx4 v[244:247], v2, s[12:15], s78 offen offset:1024 sc1
    s_waitcnt vmcnt(0)
    v_max_u32 v11, v232, v236
    v_cmp_eq_u32 vcc, -1, v11
    s_cbranch_vccnz L_O6
    s_branch L_O6_x
L_O8:
    s_sub_u32 s62, s62, 1
    s_max_i32 s62, s62, 0
    s_cmp_eq_u32 s62, 0
    s_cbranch_scc1 L_O8_x
    buffer_load_dwordx4 v[240:243], v2, s[12:15], s78 offen offset:0 sc1
    buffer_load_dwordx4 v[244:247], v2, s[12:15], s78 offen offset:1024 sc1
    s_waitcnt vmcnt(0)
    v_max3_u32 v11, v240, v242, v244
    v_max_u32 v11, v11, v246
    v_cmp_eq_u32 vcc, -1, v11
    s_cbranch_vccnz L_O8
    s_branch L_O8_x
L_ps_45:
    buffer_store_dwordx4 v[80:83], v2, s[12:15], s17 offen sc1
    buffer_store_dwordx2 v[84:85], v2, s[12:15], s18 offen sc1
    s_branch L_pj_46
L_ps_47:
    buffer_store_dwordx4 v[80:83], v2, s[12:15], s17 offen sc1
    s_branch L_pj_48
L_H0:
    s_sub_u32 s62, s62, 1
    s_max_i32 s62, s62, 0
    s_cmp_eq_u32 s62, 0
    s_cbranch_scc1 L_H0_x
    s_add_u32 m0, s79, 0
    s_nop 0
    buffer_load_dwordx4 v2, s[12:15], s16 offen offset:0 sc1 lds
    s_add_u32 m0, s79, 0
    s_nop 0
    buffer_load_dwordx4 v2, s[12:15], s16 offen offset:1024 sc1 lds
    s_waitcnt vmcnt(0)
    ds_read_b128 v[36:39], v7 offset:0
    ds_read_b128 v[40:43], v7 offset:1024
    s_waitcnt lgkmcnt(0)
    s_waitcnt vmcnt(0)
    v_max_u32 v11, v36, v40
    v_cmp_eq_u32 vcc, -1, v11
    s_cbranch_vccnz L_H0
    s_branch L_H0_x
L_H2:
    s_sub_u32 s62, s62, 1
    s_max_i32 s62, s62, 0
    s_cmp_eq_u32 s62, 0
    s_cbranch_scc1 L_H2_x
    s_add_u32 m0, s79, 0
    s_nop 0
    buffer_load_dwordx4 v2, s[12:15], s16 offen offset:2048 sc1 lds
    s_add_u32 m0, s79, 0
    s_nop 0
    buffer_load_dwordx4 v2, s[12:15], s16 offen offset:3072 sc1 lds
    s_waitcnt vmcnt(0)
    ds_read_b128 v[44:47], v7 offset:2048
    ds_read_b128 v[48:51], v7 offset:3072
    s_waitcnt lgkmcnt(0)
    s_waitcnt vmcnt(0)
    v_max_u32 v11, v44, v48
    v_cmp_eq_u32 vcc, -1, v11
    s_cbranch_vccnz L_H2
    s_branch L_H2_x
L_H4:
    s_sub_u32 s62, s62, 1
    s_max_i32 s62, s62, 0
    s_cmp_eq_u32 s62, 0
    s_cbranch_scc1 L_H4_x
    s_add_u32 m0, s79, 4096
    s_nop 0
    buffer_load_dwordx4 v2, s[12:15], s33 offen offset:0 sc1 lds
    s_add_u32 m0, s79, 4096
    s_nop 0
    buffer_load_dwordx4 v2, s[12:15], s33 offen offset:1024 sc1 lds
    s_add_u32 m0, s79, 4096
    s_nop 0
    buffer_load_dwordx4 v2, s[12:15], s33 offen offset:2048 sc1 lds
    s_add_u32 m0, s79, 4096
    s_nop 0
    buffer_load_dwordx4 v2, s[12:15], s33 offen offset:3072 sc1 lds
    s_add_u32 m0, s79, 8192
    s_nop 0
    buffer_load_dwordx4 v2, s[12:15], s78 offen offset:0 sc1 lds
    s_add_u32 m0, s79, 8192
    s_nop 0
    buffer_load_dwordx4 v2, s[12:15], s78 offen offset:1024 sc1 lds
    s_waitcnt vmcnt(0)
    ds_read_b128 v[228:231], v7 offset:4096
    ds_read_b128 v[232:235], v7 offset:5120
    s_waitcnt lgkmcnt(0)
    s_waitcnt vmcnt(0)
    v_max_u32 v11, v228, v232
    v_cmp_eq_u32 vcc, -1, v11
    s_cbranch_vccnz L_H4
    s_branch L_H4_x
L_H6:
    s_sub_u32 s62, s62, 1
    s_max_i32 s62, s62, 0
    s_cmp_eq_u32 s62, 0
    s_cbranch_scc1 L_H6_x
    s_add_u32 m0, s79, 4096
    s_nop 0
    buffer_load_dwordx4 v2, s[12:15], s33 offen offset:2048 sc1 lds
    s_add_u32 m0, s79, 4096
    s_nop 0
    buffer_load_dwordx4 v2, s[12:15], s33 offen offset:3072 sc1 lds
    s_add_u32 m0, s79, 8192
    s_nop 0
    buffer_load_dwordx4 v2, s[12:15], s78 offen offset:0 sc1 lds
    s_add_u32 m0, s79, 8192
    s_nop 0
    buffer_load_dwordx4 v2, s[12:15], s78 offen offset:1024 sc1 lds
    s_waitcnt vmcnt(0)
    ds_read_b128 v[228:231], v7 offset:6144
    ds_read_b128 v[232:235], v7 offset:7168
    s_waitcnt lgkmcnt(0)
    s_waitcnt vmcnt(0)
    v_max_u32 v11, v228, v232
    v_cmp_eq_u32 vcc, -1, v11
    s_cbranch_vccnz L_H6
    s_branch L_H6_x
L_H8:
    s_sub_u32 s62, s62, 1
    s_max_i32 s62, s62, 0
    s_cmp_eq_u32 s62, 0
    s_cbranch_scc1 L_H8_x
    s_add_u32 m0, s79, 8192
    s_nop 0
    buffer_load_dwordx4 v2, s[12:15], s78 offen offset:0 sc1 lds
    s_add_u32 m0, s79, 8192
    s_nop 0
    buffer_load_dwordx4 v2, s[12:15], s78 offen offset:1024 sc1 lds
    s_waitcnt vmcnt(0)
    ds_read_b128 v[228:231], v7 offset:8192
    ds_read_b128 v[232:235], v7 offset:9216
    s_waitcnt lgkmcnt(0)
    s_waitcnt vmcnt(0)
    v_max3_u32 v11, v228, v230, v232
    v_max_u32 v11, v11, v234
    v_cmp_eq_u32 vcc, -1, v11
    s_cbranch_vccnz L_H8
    s_branch L_H8_x
L_ps_49:
    buffer_store_dwordx4 v[12:15], v2, s[12:15], s19 offen sc1
    buffer_store_dwordx2 v[16:17], v2, s[12:15], s24 offen sc1
    s_branch L_pj_50
L_ps_51:
    buffer_store_dwordx4 v[36:39], v2, s[12:15], s19 offen sc1
    buffer_store_dwordx2 v[40:41], v2, s[12:15], s24 offen sc1
    s_branch L_pj_52
L_g0:
    s_sub_u32 s62, s62, 1
    s_max_i32 s62, s62, 0
    s_cmp_eq_u32 s62, 0
    s_cbranch_scc1 L_g0_x
    buffer_load_dwordx4 v[12:15], v2, s[12:15], s25 offen offset:0 sc1
    buffer_load_dwordx4 v[16:19], v2, s[12:15], s25 offen offset:1024 sc1
    buffer_load_dwordx4 v[20:23], v2, s[12:15], s25 offen offset:2048 sc1
    buffer_load_dwordx4 v[24:27], v2, s[12:15], s25 offen offset:3072 sc1
    s_add_u32 s65, s25, 4096
    buffer_load_dwordx4 v[28:31], v2, s[12:15], s65 offen offset:0 sc1
    s_add_u32 s65, s25, 4096
    buffer_load_dwordx4 v[32:35], v2, s[12:15], s65 offen offset:1024 sc1
    s_waitcnt vmcnt(0)
    v_max3_u32 v11, v12, v16, v20
    v_max3_u32 v11, v11, v24, v28
    v_max3_u32 v11, v11, v30, v32
    v_max_u32 v11, v11, v34
    v_cmp_eq_u32 vcc, -1, v11
    s_cbranch_vccnz L_g0
    s_branch L_g0_x
L_g1:
    s_sub_u32 s62, s62, 1
    s_max_i32 s62, s62, 0
    s_cmp_eq_u32 s62, 0
    s_cbranch_scc1 L_g1_x
    s_add_u32 s65, s16, 4096
    buffer_load_dwordx4 v[112:115], v2, s[12:15], s65 offen offset:2048 sc1
    s_add_u32 s65, s16, 4096
    buffer_load_dwordx4 v[116:119], v2, s[12:15], s65 offen offset:3072 sc1
    s_add_u32 s65, s16, 8192
    buffer_load_dwordx4 v[120:123], v2, s[12:15], s65 offen offset:0 sc1
    s_add_u32 s65, s16, 8192
    buffer_load_dwordx4 v[124:127], v2, s[12:15], s65 offen offset:1024 sc1
    s_add_u32 s65, s16, 8192
    buffer_load_dwordx4 v[128:131], v2, s[12:15], s65 offen offset:2048 sc1
    s_add_u32 s65, s16, 8192
    buffer_load_dwordx4 v[132:135], v2, s[12:15], s65 offen offset:3072 sc1
    s_waitcnt vmcnt(0)
    v_max3_u32 v11, v112, v116, v120
    v_max3_u32 v11, v11, v124, v128
    v_max3_u32 v11, v11, v130, v132
    v_max_u32 v11, v11, v134
    v_cmp_eq_u32 vcc, -1, v11
    s_cbranch_vccnz L_g1
    s_branch L_g1_x
L_g2:
    s_sub_u32 s62, s62, 1
    s_max_i32 s62, s62, 0
    s_cmp_eq_u32 s62, 0
    s_cbranch_scc1 L_g2_x
    s_add_u32 s65, s25, 12288
    buffer_load_dwordx4 v[176:179], v2, s[12:15], s65 offen offset:0 sc1
    s_add_u32 s65, s25, 12288
    buffer_load_dwordx4 v[180:183], v2, s[12:15], s65 offen offset:1024 sc1
    s_add_u32 s65, s25, 12288
    buffer_load_dwordx4 v[184:187], v2, s[12:15], s65 offen offset:2048 sc1
    s_add_u32 s65, s25, 12288
    buffer_load_dwordx4 v[188:191], v2, s[12:15], s65 offen offset:3072 sc1
    s_add_u32 s65, s25, 16384
    buffer_load_dwordx4 v[192:195], v2, s[12:15], s65 offen offset:0 sc1
    s_add_u32 s65, s25, 16384
    buffer_load_dwordx4 v[196:199], v2, s[12:15], s65 offen offset:1024 sc1
    s_waitcnt vmcnt(0)
    v_max3_u32 v11, v176, v180, v184
    v_max3_u32 v11, v11, v188, v192
    v_max3_u32 v11, v11, v194, v196
    v_max_u32 v11, v11, v198
    v_cmp_eq_u32 vcc, -1, v11
    s_cbranch_vccnz L_g2
    s_branch L_g2_x
L_g3:
    s_sub_u32 s62, s62, 1
    s_max_i32 s62, s62, 0
    s_cmp_eq_u32 s62, 0
    s_cbranch_scc1 L_g3_x
    s_add_u32 s65, s16, 16384
    buffer_load_dwordx4 v[36:39], v2, s[12:15], s65 offen offset:2048 sc1
    s_add_u32 s65, s16, 16384
    buffer_load_dwordx4 v[40:43], v2, s[12:15], s65 offen offset:3072 sc1
    s_add_u32 s65, s16, 20480
    buffer_load_dwordx4 v[44:47], v2, s[12:15], s65 offen offset:0 sc1
    s_add_u32 s65, s16, 20480
    buffer_load_dwordx4 v[48:51], v2, s[12:15], s65 offen offset:1024 sc1
    s_add_u32 s65, s16, 20480
    buffer_load_dwordx4 v[52:55], v2, s[12:15], s65 offen offset:2048 sc1
    s_add_u32 s65, s16, 20480
    buffer_load_dwordx4 v[56:59], v2, s[12:15], s65 offen offset:3072 sc1
    s_waitcnt vmcnt(0)
    v_max3_u32 v11, v36, v40, v44
    v_max3_u32 v11, v11, v48, v52
    v_max3_u32 v11, v11, v54, v56
    v_max_u32 v11, v11, v58
    v_cmp_eq_u32 vcc, -1, v11
    s_cbranch_vccnz L_g3
    s_branch L_g3_x
L_codeend:
.section .rodata,"a"
.p2align 6
.amdhsa_kernel sequential_preLN__grouped_kv_mqa__dense_activation_relu__prompt_kernel
  .amdhsa_next_free_vgpr 256
  .amdhsa_next_free_sgpr 102
  .amdhsa_accum_offset 256
  .amdhsa_group_segment_fixed_size 0
  .amdhsa_kernarg_size 88
  .amdhsa_user_sgpr_count 2
  .amdhsa_user_sgpr_kernarg_segment_ptr 1
  .amdhsa_system_sgpr_workgroup_id_x 1
.end_amdhsa_kernel
```
